```python
import torch

def _softmax(x, axis=-1):
    return torch.softmax(x, dim=axis)
def _gelu(x):
    return torch.nn.functional.gelu(x, approximate="tanh")
def _silu(x):
    return torch.nn.functional.silu(x)
def _sigmoid(x):
    return torch.sigmoid(x)
def _layernorm(x, axis=-1, eps=1e-5):
    m = x.mean(dim=axis, keepdim=True)
    v = x.var(dim=axis, keepdim=True, unbiased=False)
    return (x - m) / torch.sqrt(v + eps)
def _scatter_add(tgt, idx, src, axis=0):
    return tgt.clone().index_add_(axis, idx, src)
def _segment_sum(src, seg, n):
    out = torch.zeros((n,) + src.shape[1:], dtype=src.dtype)
    return out.index_add_(0, seg, src)
def _pad(x, pw):
    flat = tuple(v for pair in reversed(pw) for v in pair)
    return torch.nn.functional.pad(x, flat)

kernel_name = 'concat_heads__gqa_block_cached__gqa_block_cached__near_ridge'

def setup_inputs():

    _w = (lambda a: (lambda t: t.to(torch.bfloat16) if t.is_floating_point() else t)(torch.as_tensor(a)))
    def _A_setup():
        B, Sq, D = 8, 160, 576
        Hq, Hkv, Sk, Dh = 32, 16, 1024, 128
        assert Hq % Hkv == 0, (Hq, Hkv)
        return {
            "x": _w((lambda *s: torch.randn(*s, dtype=torch.bfloat16) * 0.8)(B, Sq, D)),
            "k_cache": _w((lambda *s: torch.randn(*s, dtype=torch.bfloat16) * 0.8)(B, Hkv, Sk, Dh)),
            "v_cache": _w((lambda *s: torch.randn(*s, dtype=torch.bfloat16) * 0.05)(B, Hkv, Sk, Dh)),
            "wq": _w((lambda *s: torch.randn(*s, dtype=torch.bfloat16) * 0.8)(D, Hq * Dh) * (D ** -0.5)),
            "wo": _w((lambda *s: torch.randn(*s, dtype=torch.bfloat16) * 0.05)(Hq * Dh, D) * ((Hq * Dh) ** -0.5)),
        }
    _A_in = _A_setup()

    def _B_setup():
        B, Sq, D = 8, 160, 576
        Hq, Hkv, Sk, Dh = 32, 16, 1024, 128
        assert Hq % Hkv == 0, (Hq, Hkv)
        return {
            "x": _w((lambda *s: torch.randn(*s, dtype=torch.bfloat16) * 0.8)(B, Sq, D)),
            "k_cache": _w((lambda *s: torch.randn(*s, dtype=torch.bfloat16) * 0.8)(B, Hkv, Sk, Dh)),
            "v_cache": _w((lambda *s: torch.randn(*s, dtype=torch.bfloat16) * 0.05)(B, Hkv, Sk, Dh)),
            "wq": _w((lambda *s: torch.randn(*s, dtype=torch.bfloat16) * 0.8)(D, Hq * Dh) * (D ** -0.5)),
            "wo": _w((lambda *s: torch.randn(*s, dtype=torch.bfloat16) * 0.05)(Hq * Dh, D) * ((Hq * Dh) ** -0.5)),
        }
    _B_in = _B_setup()

    return {
        "A_x": _A_in["x"],
        "A_k_cache": _A_in["k_cache"],
        "A_v_cache": _A_in["v_cache"],
        "A_wq": _A_in["wq"],
        "A_wo": _A_in["wo"],
        "B_x": _B_in["x"],
        "B_k_cache": _B_in["k_cache"],
        "B_v_cache": _B_in["v_cache"],
        "B_wq": _B_in["wq"],
        "B_wo": _B_in["wo"],
    }

def reference(A_x, A_k_cache, A_v_cache, A_wq, A_wo, B_x, B_k_cache, B_v_cache, B_wq, B_wo):
    def _A_ref(x, k_cache, v_cache, wq, wo):
        B, Sq, D = x.shape
        Hq, Dh = 32, 128
        Hkv = k_cache.shape[1]
        rep = Hq // Hkv
        q = (lambda x, *d: x.permute(*d))((x @ wq).reshape(B, Sq, Hq, Dh), 0, 2, 1, 3)
        k = (lambda x, n, axis: torch.repeat_interleave(x, n, dim=axis))(k_cache, rep, axis=1)
        v = (lambda x, n, axis: torch.repeat_interleave(x, n, dim=axis))(v_cache, rep, axis=1)
        scores = torch.einsum("bhqd,bhkd->bhqk", q, k) * (Dh ** -0.5)
        p = _softmax(scores, axis=-1)
        o = torch.einsum("bhqk,bhkd->bhqd", p, v)
        return (lambda x, *d: x.permute(*d))(o, 0, 2, 1, 3).reshape(B, Sq, Hq * Dh) @ wo

    def _B_ref(x, k_cache, v_cache, wq, wo):
        B, Sq, D = x.shape
        Hq, Dh = 32, 128
        Hkv = k_cache.shape[1]
        rep = Hq // Hkv
        q = (lambda x, *d: x.permute(*d))((x @ wq).reshape(B, Sq, Hq, Dh), 0, 2, 1, 3)
        k = (lambda x, n, axis: torch.repeat_interleave(x, n, dim=axis))(k_cache, rep, axis=1)
        v = (lambda x, n, axis: torch.repeat_interleave(x, n, dim=axis))(v_cache, rep, axis=1)
        scores = torch.einsum("bhqd,bhkd->bhqk", q, k) * (Dh ** -0.5)
        p = _softmax(scores, axis=-1)
        o = torch.einsum("bhqk,bhkd->bhqd", p, v)
        return (lambda x, *d: x.permute(*d))(o, 0, 2, 1, 3).reshape(B, Sq, Hq * Dh) @ wo

    a = _A_ref(A_x, A_k_cache, A_v_cache, A_wq, A_wo)
    b = _B_ref(B_x, B_k_cache, B_v_cache, B_wq, B_wo)
    return torch.concatenate([a, b], axis=-1)
```

```asm
; @launch kernel=concat_heads__gqa_block_cached__gqa_block_cached__near_ridge_kernel grid=(256,1,1) block=(256,1,1) lds=163840
; @launch kernel=oproj_kernel grid=(720,1,1) block=(256,1,1) lds=0
.amdgcn_target "amdgcn-amd-amdhsa--gfx950"
.text
.globl concat_heads__gqa_block_cached__gqa_block_cached__near_ridge_kernel
.p2align 8
.type concat_heads__gqa_block_cached__gqa_block_cached__near_ridge_kernel,@function
concat_heads__gqa_block_cached__gqa_block_cached__near_ridge_kernel:
    s_cmp_ge_u32 s2, 256
    s_cbranch_scc1 L_k1_end
    s_load_dwordx16 s[32:47], s[0:1], 0
    s_load_dwordx8 s[48:55], s[0:1], 64
    s_load_dwordx2 s[56:57], s[0:1], 96
    s_getpc_b64 s[58:59]
L_pc:
    v_lshlrev_b32 v28, 7, v0
    s_sub_u32 s58, s58, L_pc-concat_heads__gqa_block_cached__gqa_block_cached__near_ridge_kernel
    s_subb_u32 s59, s59, 0
    v_min_u32 v28, L_code_end-concat_heads__gqa_block_cached__gqa_block_cached__near_ridge_kernel-4, v28
    v_mov_b32 v29, s59
    v_add_co_u32 v28, vcc, s58, v28
    v_addc_co_u32 v29, vcc, 0, v29, vcc
    global_load_dword v30, v[28:29], off
    v_and_b32 v80, 63, v0
    v_lshrrev_b32 v1, 6, v0
    s_and_b32 s29, s2, 7
    v_readfirstlane_b32 s28, v1
    s_lshr_b32 s29, s29, 2
    s_lshr_b32 s61, s2, 3
    s_and_b32 s30, s61, 7
    s_lshr_b32 s61, s61, 3
    s_and_b32 s31, s2, 3
    s_lshl_b32 s31, s31, 2
    s_add_u32 s31, s31, s61
    v_and_b32 v8, 3, v80
    v_lshrrev_b32 v13, 2, v80
    v_and_b32 v13, 7, v13
    v_lshrrev_b32 v14, 1, v13
    v_and_b32 v14, 2, v14
    v_xor_b32 v14, v14, v8
    v_lshlrev_b32 v14, 4, v14
    v_lshrrev_b32 v20, 5, v80
    v_lshl_add_u32 v15, v20, 6, v14
    s_movk_i32 s62, 1152
    v_mad_u32_u24 v89, v13, s62, v15
    v_lshlrev_b32 v22, 6, v20
    v_lshl_add_u32 v22, v8, 4, v22
    v_lshl_add_u32 v90, v13, 13, v22
    s_mul_i32 s64, s28, 46080
    s_lshl_b32 s65, s28, 17
    s_waitcnt lgkmcnt(0)
    s_cmp_eq_u32 s29, 0
    s_cselect_b32 s4, s32, s42
    s_cselect_b32 s5, s33, s43
    s_cselect_b32 s8, s38, s48
    s_cselect_b32 s9, s39, s49
    s_cselect_b32 s12, s34, s44
    s_cselect_b32 s13, s35, s45
    s_cselect_b32 s16, s36, s46
    s_cselect_b32 s17, s37, s47
    s_cselect_b32 s24, s40, s50
    s_cselect_b32 s25, s41, s51
    s_mul_i32 s61, s30, 184320
    s_add_u32 s4, s4, s61
    s_addc_u32 s5, s5, 0
    s_mov_b32 s6, 184320
    s_mov_b32 s7, 0x20000
    s_lshl_b32 s61, s31, 9
    s_add_u32 s8, s8, s61
    s_addc_u32 s9, s9, 0
    s_sub_u32 s10, 4718592, s61
    s_mov_b32 s11, 0x20000
    s_and_b32 s5, s5, 0xffff
    s_and_b32 s9, s9, 0xffff
    s_mov_b32 s67, 4096
    s_mul_i32 s40, s28, 5120
    s_add_u32 s40, s40, s67
    s_lshl_b32 s41, s28, 13
    s_add_u32 s41, s41, s67
    s_add_u32 m0, s40, 0
    s_mov_b32 s61, s64
    buffer_load_dwordx4 v89, s[4:7], s61 offen  lds
    s_add_u32 m0, s40, 1024
    s_add_u32 s61, s64, 9216
    buffer_load_dwordx4 v89, s[4:7], s61 offen  lds
    s_add_u32 m0, s40, 2048
    s_add_u32 s61, s64, 18432
    buffer_load_dwordx4 v89, s[4:7], s61 offen  lds
    s_add_u32 m0, s40, 3072
    s_add_u32 s61, s64, 27648
    buffer_load_dwordx4 v89, s[4:7], s61 offen  lds
    s_add_u32 m0, s40, 4096
    s_add_u32 s61, s64, 36864
    buffer_load_dwordx4 v89, s[4:7], s61 offen  lds
    s_add_u32 m0, s41, 20480
    s_mov_b32 s61, s65
    buffer_load_dwordx4 v90, s[8:11], s61 offen  lds
    s_add_u32 m0, s41, 21504
    s_add_u32 s61, s65, 128
    buffer_load_dwordx4 v90, s[8:11], s61 offen  lds
    s_add_u32 m0, s41, 22528
    s_add_u32 s61, s65, 256
    buffer_load_dwordx4 v90, s[8:11], s61 offen  lds
    s_add_u32 m0, s41, 23552
    s_add_u32 s61, s65, 384
    buffer_load_dwordx4 v90, s[8:11], s61 offen  lds
    s_add_u32 m0, s41, 24576
    s_add_u32 s61, s65, 65536
    buffer_load_dwordx4 v90, s[8:11], s61 offen  lds
    s_add_u32 m0, s41, 25600
    s_add_u32 s61, s65, 65664
    buffer_load_dwordx4 v90, s[8:11], s61 offen  lds
    s_add_u32 m0, s41, 26624
    s_add_u32 s61, s65, 65792
    buffer_load_dwordx4 v90, s[8:11], s61 offen  lds
    s_add_u32 m0, s41, 27648
    s_add_u32 s61, s65, 65920
    buffer_load_dwordx4 v90, s[8:11], s61 offen  lds
    s_add_u32 s64, s64, 128
    s_add_u32 s65, s65, 524288
    v_lshrrev_b32 v2, 4, v80
    v_and_b32 v3, 15, v80
    v_lshrrev_b32 v4, 3, v3
    v_and_b32 v5, 7, v3
    v_lshrrev_b32 v6, 1, v3
    v_and_b32 v6, 2, v6
    v_xor_b32 v6, v6, v2
    v_lshlrev_b32 v6, 4, v6
    v_lshl_add_u32 v6, v5, 6, v6
    v_lshl_add_u32 v81, v4, 11, v6
    v_lshl_add_u32 v87, v4, 10, v6
    v_lshrrev_b32 v7, 2, v80
    v_and_b32 v7, 3, v7
    v_lshrrev_b32 v9, 1, v2
    v_and_b32 v10, 1, v2
    v_lshl_add_u32 v11, v10, 2, v7
    v_lshlrev_b32 v11, 6, v11
    v_lshl_add_u32 v11, v8, 3, v11
    v_lshl_add_u32 v11, v9, 11, v11
    v_lshl_add_u32 v82, v10, 5, v11
    v_lshlrev_b32 v12, 12, v2
    v_lshl_add_u32 v12, v7, 6, v12
    v_lshl_add_u32 v88, v8, 4, v12
    v_lshl_add_u32 v83, v13, 8, v15
    v_mov_b32 v92, 0x3e0293ee
    v_mov_b32 v93, 0x3e0293ee
    v_mov_b32 v24, 0
    v_mov_b32 v25, 0
    v_mov_b32 v26, 0
    v_mov_b32 v27, 0
    s_and_b32 s61, s28, 1
    s_lshr_b32 s62, s28, 1
    s_lshl_b32 s73, s62, 12
    s_lshl_b32 s63, s61, 10
    s_add_u32 s73, s73, s63
    s_lshl_b32 s63, s62, 12
    s_lshl_b32 s76, s61, 7
    s_add_u32 s63, s63, s76
    v_add_u32 v83, s63, v83
    s_mul_i32 s63, s61, 10240
    v_add_u32 v87, s63, v87
    s_lshl_b32 s63, s62, 11
    s_add_u32 s63, s63, 20480
    v_add_u32 v88, s63, v88
    s_lshl_b32 s62, s30, 4
    s_add_u32 s62, s62, s31
    s_lshl_b32 s61, s62, 18
    s_add_u32 s12, s12, s61
    s_addc_u32 s13, s13, 0
    s_mov_b32 s14, 262144
    s_mov_b32 s15, 0x20000
    s_add_u32 s16, s16, s61
    s_addc_u32 s17, s17, 0
    s_mov_b32 s18, 262144
    s_mov_b32 s19, 0x20000
    s_mul_i32 s61, s31, 294912
    s_add_u32 s24, s24, s61
    s_addc_u32 s25, s25, 0
    s_mov_b32 s26, 294912
    s_mov_b32 s27, 0x20000
    s_add_u32 s20, s56, 0
    s_addc_u32 s21, s57, 0
    s_mov_b32 s22, 47185920
    s_mov_b32 s23, 0x20000
    s_mov_b32 s72, 0
    s_and_b32 s13, s13, 0xffff
    s_and_b32 s17, s17, 0xffff
    s_and_b32 s25, s25, 0xffff
    s_and_b32 s21, s21, 0xffff
    v_mfma_f32_32x32x16_bf16 a[0:15], v[24:27], v[24:27], 0
    v_mfma_f32_32x32x16_bf16 a[16:31], v[24:27], v[24:27], 0
    v_mfma_f32_32x32x16_bf16 a[32:47], v[24:27], v[24:27], 0
    v_mfma_f32_32x32x16_bf16 a[48:63], v[24:27], v[24:27], 0
    v_mfma_f32_32x32x16_bf16 a[64:79], v[24:27], v[24:27], 0
    v_mfma_f32_32x32x16_bf16 a[80:95], v[24:27], v[24:27], 0
    v_mfma_f32_32x32x16_bf16 a[96:111], v[24:27], v[24:27], 0
    v_mfma_f32_32x32x16_bf16 a[112:127], v[24:27], v[24:27], 0
    v_mfma_f32_32x32x16_bf16 a[128:143], v[24:27], v[24:27], 0
    v_mfma_f32_32x32x16_bf16 a[144:159], v[24:27], v[24:27], 0
    v_mfma_f32_32x32x16_bf16 a[160:175], v[24:27], v[24:27], 0
    v_mfma_f32_32x32x16_bf16 a[176:191], v[24:27], v[24:27], 0
    v_mfma_f32_32x32x16_bf16 a[192:207], v[24:27], v[24:27], 0
    v_mfma_f32_32x32x16_bf16 a[208:223], v[24:27], v[24:27], 0
    v_mfma_f32_32x32x16_bf16 a[224:239], v[24:27], v[24:27], 0
    v_mfma_f32_32x32x16_bf16 a[240:255], v[24:27], v[24:27], 0
    v_mfma_f32_32x32x16_bf16 v[96:111], v[24:27], v[24:27], 0
    v_mfma_f32_32x32x16_bf16 v[112:127], v[24:27], v[24:27], 0
    v_mfma_f32_32x32x16_bf16 v[128:143], v[24:27], v[24:27], 0
    v_mfma_f32_32x32x16_bf16 v[144:159], v[24:27], v[24:27], 0
    v_mfma_f32_32x32x16_bf16 v[160:175], v[24:27], v[24:27], 0
    v_mfma_f32_32x32x16_bf16 v[176:191], v[24:27], v[24:27], 0
    v_mfma_f32_32x32x16_bf16 v[192:207], v[24:27], v[24:27], 0
    v_mfma_f32_32x32x16_bf16 v[208:223], v[24:27], v[24:27], 0
    v_mfma_f32_32x32x16_bf16 v[224:239], v[24:27], v[24:27], 0
    v_mfma_f32_32x32x16_bf16 v[240:255], v[24:27], v[24:27], 0
    s_nop 1
    v_mov_b32 v24, 0x3f803f80
    v_accvgpr_write_b32 a244, v24
    v_accvgpr_write_b32 a245, v24
    v_accvgpr_write_b32 a246, v24
    v_accvgpr_write_b32 a247, v24
    s_mov_b32 s67, 57344
    s_mul_i32 s40, s28, 5120
    s_add_u32 s40, s40, s67
    s_lshl_b32 s41, s28, 13
    s_add_u32 s41, s41, s67
    s_add_u32 m0, s40, 0
    s_mov_b32 s61, s64
    buffer_load_dwordx4 v89, s[4:7], s61 offen  lds
    s_add_u32 m0, s40, 1024
    s_add_u32 s61, s64, 9216
    buffer_load_dwordx4 v89, s[4:7], s61 offen  lds
    s_add_u32 m0, s40, 2048
    s_add_u32 s61, s64, 18432
    buffer_load_dwordx4 v89, s[4:7], s61 offen  lds
    s_add_u32 m0, s40, 3072
    s_add_u32 s61, s64, 27648
    buffer_load_dwordx4 v89, s[4:7], s61 offen  lds
    s_add_u32 m0, s40, 4096
    s_add_u32 s61, s64, 36864
    buffer_load_dwordx4 v89, s[4:7], s61 offen  lds
    s_add_u32 m0, s41, 20480
    s_mov_b32 s61, s65
    buffer_load_dwordx4 v90, s[8:11], s61 offen  lds
    s_add_u32 m0, s41, 21504
    s_add_u32 s61, s65, 128
    buffer_load_dwordx4 v90, s[8:11], s61 offen  lds
    s_add_u32 m0, s41, 22528
    s_add_u32 s61, s65, 256
    buffer_load_dwordx4 v90, s[8:11], s61 offen  lds
    s_add_u32 m0, s41, 23552
    s_add_u32 s61, s65, 384
    buffer_load_dwordx4 v90, s[8:11], s61 offen  lds
    s_add_u32 m0, s41, 24576
    s_add_u32 s61, s65, 65536
    buffer_load_dwordx4 v90, s[8:11], s61 offen  lds
    s_add_u32 m0, s41, 25600
    s_add_u32 s61, s65, 65664
    buffer_load_dwordx4 v90, s[8:11], s61 offen  lds
    s_add_u32 m0, s41, 26624
    s_add_u32 s61, s65, 65792
    buffer_load_dwordx4 v90, s[8:11], s61 offen  lds
    s_add_u32 m0, s41, 27648
    s_add_u32 s61, s65, 65920
    buffer_load_dwordx4 v90, s[8:11], s61 offen  lds
    s_add_u32 s64, s64, 128
    s_add_u32 s65, s65, 524288
    s_mov_b32 s67, 110592
    s_mul_i32 s40, s28, 5120
    s_add_u32 s40, s40, s67
    s_lshl_b32 s41, s28, 13
    s_add_u32 s41, s41, s67
    s_add_u32 m0, s40, 0
    s_mov_b32 s61, s64
    buffer_load_dwordx4 v89, s[4:7], s61 offen  lds
    s_add_u32 m0, s40, 1024
    s_add_u32 s61, s64, 9216
    buffer_load_dwordx4 v89, s[4:7], s61 offen  lds
    s_add_u32 m0, s40, 2048
    s_add_u32 s61, s64, 18432
    buffer_load_dwordx4 v89, s[4:7], s61 offen  lds
    s_add_u32 m0, s40, 3072
    s_add_u32 s61, s64, 27648
    buffer_load_dwordx4 v89, s[4:7], s61 offen  lds
    s_add_u32 m0, s40, 4096
    s_add_u32 s61, s64, 36864
    buffer_load_dwordx4 v89, s[4:7], s61 offen  lds
    s_add_u32 m0, s41, 20480
    s_mov_b32 s61, s65
    buffer_load_dwordx4 v90, s[8:11], s61 offen  lds
    s_add_u32 m0, s41, 21504
    s_add_u32 s61, s65, 128
    buffer_load_dwordx4 v90, s[8:11], s61 offen  lds
    s_mov_b32 s66, 4096
    v_add_u32 v85, s66, v87
    v_add_u32 v86, s66, v88
    s_waitcnt vmcnt(20)
    s_barrier
    ds_read_b128 v[32:35], v85 offset:0
    ds_read_b128 v[36:39], v85 offset:2048
    ds_read_b128 v[40:43], v85 offset:4096
    ds_read_b128 v[44:47], v85 offset:6144
    ds_read_b128 v[48:51], v85 offset:8192
    ds_read_b64_tr_b16 v[0:1], v86 offset:0
    ds_read_b64_tr_b16 v[2:3], v86 offset:256
    ds_read_b64_tr_b16 v[4:5], v86 offset:8
    ds_read_b64_tr_b16 v[6:7], v86 offset:264
    ds_read_b64_tr_b16 v[8:9], v86 offset:512
    ds_read_b64_tr_b16 v[10:11], v86 offset:768
    ds_read_b64_tr_b16 v[12:13], v86 offset:520
    ds_read_b64_tr_b16 v[14:15], v86 offset:776
    ds_read_b64_tr_b16 v[16:17], v86 offset:1024
    ds_read_b64_tr_b16 v[18:19], v86 offset:1280
    ds_read_b64_tr_b16 v[20:21], v86 offset:1032
    ds_read_b64_tr_b16 v[22:23], v86 offset:1288
    ds_read_b64_tr_b16 v[24:25], v86 offset:1536
    ds_read_b64_tr_b16 v[26:27], v86 offset:1792
    ds_read_b64_tr_b16 v[28:29], v86 offset:1544
    ds_read_b64_tr_b16 v[30:31], v86 offset:1800
    s_mov_b32 s60, 6
    s_waitcnt lgkmcnt(2)
L_q1:
    s_waitcnt lgkmcnt(2)
    v_mfma_f32_16x16x32_bf16 v[96:99], v[0:3], v[32:35], v[96:99]
    ds_read_b128 v[52:55], v85 offset:512
    s_add_u32 s42, s66, 53248
    v_mfma_f32_16x16x32_bf16 v[128:131], v[0:3], v[36:39], v[128:131]
    ds_read_b128 v[56:59], v85 offset:2560
    v_mfma_f32_16x16x32_bf16 v[160:163], v[0:3], v[40:43], v[160:163]
    ds_read_b128 v[60:63], v85 offset:4608
    v_mfma_f32_16x16x32_bf16 v[192:195], v[0:3], v[44:47], v[192:195]
    ds_read_b128 v[64:67], v85 offset:6656
    s_add_u32 m0, s41, 22528
    v_mfma_f32_16x16x32_bf16 v[224:227], v[0:3], v[48:51], v[224:227]
    ds_read_b128 v[68:71], v85 offset:8704
    s_add_u32 s61, s65, 256
    v_mfma_f32_16x16x32_bf16 v[100:103], v[4:7], v[32:35], v[100:103]
    ds_read_b64_tr_b16 v[0:1], v86 offset:16384
    buffer_load_dwordx4 v90, s[8:11], s61 offen  lds
    v_mfma_f32_16x16x32_bf16 v[132:135], v[4:7], v[36:39], v[132:135]
    ds_read_b64_tr_b16 v[2:3], v86 offset:16640
    v_mfma_f32_16x16x32_bf16 v[164:167], v[4:7], v[40:43], v[164:167]
    s_cmp_eq_u32 s42, 163840
    s_cselect_b32 s42, 4096, s42
    v_mfma_f32_16x16x32_bf16 v[196:199], v[4:7], v[44:47], v[196:199]
    s_add_u32 m0, s41, 23552
    s_add_u32 s61, s65, 384
    v_mfma_f32_16x16x32_bf16 v[228:231], v[4:7], v[48:51], v[228:231]
    buffer_load_dwordx4 v90, s[8:11], s61 offen  lds
    v_mfma_f32_16x16x32_bf16 v[104:107], v[8:11], v[32:35], v[104:107]
    ds_read_b64_tr_b16 v[4:5], v86 offset:16392
    v_mfma_f32_16x16x32_bf16 v[136:139], v[8:11], v[36:39], v[136:139]
    ds_read_b64_tr_b16 v[6:7], v86 offset:16648
    v_mfma_f32_16x16x32_bf16 v[168:171], v[8:11], v[40:43], v[168:171]
    s_add_u32 m0, s41, 24576
    s_add_u32 s61, s65, 65536
    v_mfma_f32_16x16x32_bf16 v[200:203], v[8:11], v[44:47], v[200:203]
    buffer_load_dwordx4 v90, s[8:11], s61 offen  lds
    v_mfma_f32_16x16x32_bf16 v[232:235], v[8:11], v[48:51], v[232:235]
    v_mfma_f32_16x16x32_bf16 v[108:111], v[12:15], v[32:35], v[108:111]
    ds_read_b64_tr_b16 v[8:9], v86 offset:16896
    v_mfma_f32_16x16x32_bf16 v[140:143], v[12:15], v[36:39], v[140:143]
    ds_read_b64_tr_b16 v[10:11], v86 offset:17152
    s_add_u32 m0, s41, 25600
    v_mfma_f32_16x16x32_bf16 v[172:175], v[12:15], v[40:43], v[172:175]
    s_add_u32 s61, s65, 65664
    buffer_load_dwordx4 v90, s[8:11], s61 offen  lds
    v_mfma_f32_16x16x32_bf16 v[204:207], v[12:15], v[44:47], v[204:207]
    v_mfma_f32_16x16x32_bf16 v[236:239], v[12:15], v[48:51], v[236:239]
    v_mfma_f32_16x16x32_bf16 v[112:115], v[16:19], v[32:35], v[112:115]
    ds_read_b64_tr_b16 v[12:13], v86 offset:16904
    v_mfma_f32_16x16x32_bf16 v[144:147], v[16:19], v[36:39], v[144:147]
    ds_read_b64_tr_b16 v[14:15], v86 offset:17160
    s_add_u32 m0, s41, 26624
    v_mfma_f32_16x16x32_bf16 v[176:179], v[16:19], v[40:43], v[176:179]
    s_add_u32 s61, s65, 65792
    buffer_load_dwordx4 v90, s[8:11], s61 offen  lds
    v_mfma_f32_16x16x32_bf16 v[208:211], v[16:19], v[44:47], v[208:211]
    v_mfma_f32_16x16x32_bf16 v[240:243], v[16:19], v[48:51], v[240:243]
    v_mfma_f32_16x16x32_bf16 v[116:119], v[20:23], v[32:35], v[116:119]
    ds_read_b64_tr_b16 v[16:17], v86 offset:17408
    s_add_u32 m0, s41, 27648
    v_mfma_f32_16x16x32_bf16 v[148:151], v[20:23], v[36:39], v[148:151]
    ds_read_b64_tr_b16 v[18:19], v86 offset:17664
    s_add_u32 s61, s65, 65920
    v_mfma_f32_16x16x32_bf16 v[180:183], v[20:23], v[40:43], v[180:183]
    buffer_load_dwordx4 v90, s[8:11], s61 offen  lds
    s_add_u32 s64, s64, 128
    v_mfma_f32_16x16x32_bf16 v[212:215], v[20:23], v[44:47], v[212:215]
    s_add_u32 s65, s65, 524288
    v_mfma_f32_16x16x32_bf16 v[244:247], v[20:23], v[48:51], v[244:247]
    v_mfma_f32_16x16x32_bf16 v[120:123], v[24:27], v[32:35], v[120:123]
    ds_read_b64_tr_b16 v[20:21], v86 offset:17416
    v_mfma_f32_16x16x32_bf16 v[152:155], v[24:27], v[36:39], v[152:155]
    ds_read_b64_tr_b16 v[22:23], v86 offset:17672
    v_mfma_f32_16x16x32_bf16 v[184:187], v[24:27], v[40:43], v[184:187]
    v_mfma_f32_16x16x32_bf16 v[216:219], v[24:27], v[44:47], v[216:219]
    v_mfma_f32_16x16x32_bf16 v[248:251], v[24:27], v[48:51], v[248:251]
    s_waitcnt lgkmcnt(2)
    v_mfma_f32_16x16x32_bf16 v[124:127], v[28:31], v[32:35], v[124:127]
    ds_read_b64_tr_b16 v[24:25], v86 offset:17920
    v_mfma_f32_16x16x32_bf16 v[156:159], v[28:31], v[36:39], v[156:159]
    ds_read_b64_tr_b16 v[26:27], v86 offset:18176
    v_mfma_f32_16x16x32_bf16 v[188:191], v[28:31], v[40:43], v[188:191]
    v_mfma_f32_16x16x32_bf16 v[220:223], v[28:31], v[44:47], v[220:223]
    v_mfma_f32_16x16x32_bf16 v[252:255], v[28:31], v[48:51], v[252:255]
    ds_read_b64_tr_b16 v[28:29], v86 offset:17928
    ds_read_b64_tr_b16 v[30:31], v86 offset:18184
    s_waitcnt lgkmcnt(2)
    v_mfma_f32_16x16x32_bf16 v[96:99], v[0:3], v[52:55], v[96:99]
    v_mfma_f32_16x16x32_bf16 v[128:131], v[0:3], v[56:59], v[128:131]
    v_mfma_f32_16x16x32_bf16 v[160:163], v[0:3], v[60:63], v[160:163]
    v_mfma_f32_16x16x32_bf16 v[192:195], v[0:3], v[64:67], v[192:195]
    v_mfma_f32_16x16x32_bf16 v[224:227], v[0:3], v[68:71], v[224:227]
    s_waitcnt vmcnt(13) lgkmcnt(0)
    s_barrier
    v_add_u32 v86, s42, v88
    v_add_u32 v85, s42, v87
    v_mfma_f32_16x16x32_bf16 v[100:103], v[4:7], v[52:55], v[100:103]
    ds_read_b64_tr_b16 v[0:1], v86 offset:0
    ds_read_b64_tr_b16 v[2:3], v86 offset:256
    v_mfma_f32_16x16x32_bf16 v[132:135], v[4:7], v[56:59], v[132:135]
    s_mov_b32 s67, s66
    s_mov_b32 s66, s42
    v_mfma_f32_16x16x32_bf16 v[164:167], v[4:7], v[60:63], v[164:167]
    ds_read_b128 v[32:35], v85 offset:0
    s_mul_i32 s40, s28, 5120
    v_mfma_f32_16x16x32_bf16 v[196:199], v[4:7], v[64:67], v[196:199]
    ds_read_b128 v[36:39], v85 offset:2048
    s_add_u32 s40, s40, s67
    v_mfma_f32_16x16x32_bf16 v[228:231], v[4:7], v[68:71], v[228:231]
    ds_read_b128 v[40:43], v85 offset:4096
    s_lshl_b32 s41, s28, 13
    v_mfma_f32_16x16x32_bf16 v[104:107], v[8:11], v[52:55], v[104:107]
    ds_read_b64_tr_b16 v[4:5], v86 offset:8
    ds_read_b128 v[44:47], v85 offset:6144
    v_mfma_f32_16x16x32_bf16 v[136:139], v[8:11], v[56:59], v[136:139]
    ds_read_b64_tr_b16 v[6:7], v86 offset:264
    ds_read_b128 v[48:51], v85 offset:8192
    v_mfma_f32_16x16x32_bf16 v[168:171], v[8:11], v[60:63], v[168:171]
    s_add_u32 s41, s41, s67
    s_add_u32 m0, s40, 0
    v_mfma_f32_16x16x32_bf16 v[200:203], v[8:11], v[64:67], v[200:203]
    s_mov_b32 s61, s64
    buffer_load_dwordx4 v89, s[4:7], s61 offen  lds
    v_mfma_f32_16x16x32_bf16 v[232:235], v[8:11], v[68:71], v[232:235]
    v_mfma_f32_16x16x32_bf16 v[108:111], v[12:15], v[52:55], v[108:111]
    ds_read_b64_tr_b16 v[8:9], v86 offset:512
    s_add_u32 m0, s40, 1024
    v_mfma_f32_16x16x32_bf16 v[140:143], v[12:15], v[56:59], v[140:143]
    ds_read_b64_tr_b16 v[10:11], v86 offset:768
    s_add_u32 s61, s64, 9216
    v_mfma_f32_16x16x32_bf16 v[172:175], v[12:15], v[60:63], v[172:175]
    buffer_load_dwordx4 v89, s[4:7], s61 offen  lds
    v_mfma_f32_16x16x32_bf16 v[204:207], v[12:15], v[64:67], v[204:207]
    s_add_u32 m0, s40, 2048
    s_add_u32 s61, s64, 18432
    v_mfma_f32_16x16x32_bf16 v[236:239], v[12:15], v[68:71], v[236:239]
    buffer_load_dwordx4 v89, s[4:7], s61 offen  lds
    v_mfma_f32_16x16x32_bf16 v[112:115], v[16:19], v[52:55], v[112:115]
    ds_read_b64_tr_b16 v[12:13], v86 offset:520
    v_mfma_f32_16x16x32_bf16 v[144:147], v[16:19], v[56:59], v[144:147]
    ds_read_b64_tr_b16 v[14:15], v86 offset:776
    v_mfma_f32_16x16x32_bf16 v[176:179], v[16:19], v[60:63], v[176:179]
    s_add_u32 m0, s40, 3072
    s_add_u32 s61, s64, 27648
    v_mfma_f32_16x16x32_bf16 v[208:211], v[16:19], v[64:67], v[208:211]
    buffer_load_dwordx4 v89, s[4:7], s61 offen  lds
    v_mfma_f32_16x16x32_bf16 v[240:243], v[16:19], v[68:71], v[240:243]
    v_mfma_f32_16x16x32_bf16 v[116:119], v[20:23], v[52:55], v[116:119]
    ds_read_b64_tr_b16 v[16:17], v86 offset:1024
    s_add_u32 m0, s40, 4096
    v_mfma_f32_16x16x32_bf16 v[148:151], v[20:23], v[56:59], v[148:151]
    ds_read_b64_tr_b16 v[18:19], v86 offset:1280
    s_add_u32 s61, s64, 36864
    v_mfma_f32_16x16x32_bf16 v[180:183], v[20:23], v[60:63], v[180:183]
    buffer_load_dwordx4 v89, s[4:7], s61 offen  lds
    v_mfma_f32_16x16x32_bf16 v[212:215], v[20:23], v[64:67], v[212:215]
    v_mfma_f32_16x16x32_bf16 v[244:247], v[20:23], v[68:71], v[244:247]
    s_add_u32 m0, s41, 20480
    s_mov_b32 s61, s65
    v_mfma_f32_16x16x32_bf16 v[120:123], v[24:27], v[52:55], v[120:123]
    ds_read_b64_tr_b16 v[20:21], v86 offset:1032
    buffer_load_dwordx4 v90, s[8:11], s61 offen  lds
    v_mfma_f32_16x16x32_bf16 v[152:155], v[24:27], v[56:59], v[152:155]
    ds_read_b64_tr_b16 v[22:23], v86 offset:1288
    v_mfma_f32_16x16x32_bf16 v[184:187], v[24:27], v[60:63], v[184:187]
    s_add_u32 m0, s41, 21504
    s_add_u32 s61, s65, 128
    v_mfma_f32_16x16x32_bf16 v[216:219], v[24:27], v[64:67], v[216:219]
    buffer_load_dwordx4 v90, s[8:11], s61 offen  lds
    v_mfma_f32_16x16x32_bf16 v[248:251], v[24:27], v[68:71], v[248:251]
    v_mfma_f32_16x16x32_bf16 v[124:127], v[28:31], v[52:55], v[124:127]
    ds_read_b64_tr_b16 v[24:25], v86 offset:1536
    v_mfma_f32_16x16x32_bf16 v[156:159], v[28:31], v[56:59], v[156:159]
    ds_read_b64_tr_b16 v[26:27], v86 offset:1792
    v_mfma_f32_16x16x32_bf16 v[188:191], v[28:31], v[60:63], v[188:191]
    v_mfma_f32_16x16x32_bf16 v[220:223], v[28:31], v[64:67], v[220:223]
    v_mfma_f32_16x16x32_bf16 v[252:255], v[28:31], v[68:71], v[252:255]
    ds_read_b64_tr_b16 v[28:29], v86 offset:1544
    ds_read_b64_tr_b16 v[30:31], v86 offset:1800
    s_sub_u32 s60, s60, 1
    s_cmp_lg_u32 s60, 0
    s_cbranch_scc1 L_q1
    s_waitcnt lgkmcnt(2)
    v_mfma_f32_16x16x32_bf16 v[96:99], v[0:3], v[32:35], v[96:99]
    ds_read_b128 v[52:55], v85 offset:512
    s_add_u32 s42, s66, 53248
    v_mfma_f32_16x16x32_bf16 v[128:131], v[0:3], v[36:39], v[128:131]
    ds_read_b128 v[56:59], v85 offset:2560
    v_mfma_f32_16x16x32_bf16 v[160:163], v[0:3], v[40:43], v[160:163]
    ds_read_b128 v[60:63], v85 offset:4608
    v_mfma_f32_16x16x32_bf16 v[192:195], v[0:3], v[44:47], v[192:195]
    ds_read_b128 v[64:67], v85 offset:6656
    s_add_u32 m0, s41, 22528
    v_mfma_f32_16x16x32_bf16 v[224:227], v[0:3], v[48:51], v[224:227]
    ds_read_b128 v[68:71], v85 offset:8704
    s_add_u32 s61, s65, 256
    v_mfma_f32_16x16x32_bf16 v[100:103], v[4:7], v[32:35], v[100:103]
    ds_read_b64_tr_b16 v[0:1], v86 offset:16384
    buffer_load_dwordx4 v90, s[8:11], s61 offen  lds
    v_mfma_f32_16x16x32_bf16 v[132:135], v[4:7], v[36:39], v[132:135]
    ds_read_b64_tr_b16 v[2:3], v86 offset:16640
    v_mfma_f32_16x16x32_bf16 v[164:167], v[4:7], v[40:43], v[164:167]
    s_cmp_eq_u32 s42, 163840
    s_cselect_b32 s42, 4096, s42
    v_mfma_f32_16x16x32_bf16 v[196:199], v[4:7], v[44:47], v[196:199]
    s_add_u32 m0, s41, 23552
    s_add_u32 s61, s65, 384
    v_mfma_f32_16x16x32_bf16 v[228:231], v[4:7], v[48:51], v[228:231]
    buffer_load_dwordx4 v90, s[8:11], s61 offen  lds
    v_mfma_f32_16x16x32_bf16 v[104:107], v[8:11], v[32:35], v[104:107]
    ds_read_b64_tr_b16 v[4:5], v86 offset:16392
    v_mfma_f32_16x16x32_bf16 v[136:139], v[8:11], v[36:39], v[136:139]
    ds_read_b64_tr_b16 v[6:7], v86 offset:16648
    v_mfma_f32_16x16x32_bf16 v[168:171], v[8:11], v[40:43], v[168:171]
    s_add_u32 m0, s41, 24576
    s_add_u32 s61, s65, 65536
    v_mfma_f32_16x16x32_bf16 v[200:203], v[8:11], v[44:47], v[200:203]
    buffer_load_dwordx4 v90, s[8:11], s61 offen  lds
    v_mfma_f32_16x16x32_bf16 v[232:235], v[8:11], v[48:51], v[232:235]
    v_mfma_f32_16x16x32_bf16 v[108:111], v[12:15], v[32:35], v[108:111]
    ds_read_b64_tr_b16 v[8:9], v86 offset:16896
    v_mfma_f32_16x16x32_bf16 v[140:143], v[12:15], v[36:39], v[140:143]
    ds_read_b64_tr_b16 v[10:11], v86 offset:17152
    s_add_u32 m0, s41, 25600
    v_mfma_f32_16x16x32_bf16 v[172:175], v[12:15], v[40:43], v[172:175]
    s_add_u32 s61, s65, 65664
    buffer_load_dwordx4 v90, s[8:11], s61 offen  lds
    v_mfma_f32_16x16x32_bf16 v[204:207], v[12:15], v[44:47], v[204:207]
    v_mfma_f32_16x16x32_bf16 v[236:239], v[12:15], v[48:51], v[236:239]
    v_mfma_f32_16x16x32_bf16 v[112:115], v[16:19], v[32:35], v[112:115]
    ds_read_b64_tr_b16 v[12:13], v86 offset:16904
    v_mfma_f32_16x16x32_bf16 v[144:147], v[16:19], v[36:39], v[144:147]
    ds_read_b64_tr_b16 v[14:15], v86 offset:17160
    s_add_u32 m0, s41, 26624
    v_mfma_f32_16x16x32_bf16 v[176:179], v[16:19], v[40:43], v[176:179]
    s_add_u32 s61, s65, 65792
    buffer_load_dwordx4 v90, s[8:11], s61 offen  lds
    v_mfma_f32_16x16x32_bf16 v[208:211], v[16:19], v[44:47], v[208:211]
    v_mfma_f32_16x16x32_bf16 v[240:243], v[16:19], v[48:51], v[240:243]
    v_mfma_f32_16x16x32_bf16 v[116:119], v[20:23], v[32:35], v[116:119]
    ds_read_b64_tr_b16 v[16:17], v86 offset:17408
    s_add_u32 m0, s41, 27648
    v_mfma_f32_16x16x32_bf16 v[148:151], v[20:23], v[36:39], v[148:151]
    ds_read_b64_tr_b16 v[18:19], v86 offset:17664
    s_add_u32 s61, s65, 65920
    v_mfma_f32_16x16x32_bf16 v[180:183], v[20:23], v[40:43], v[180:183]
    buffer_load_dwordx4 v90, s[8:11], s61 offen  lds
    s_add_u32 s64, s64, 128
    v_mfma_f32_16x16x32_bf16 v[212:215], v[20:23], v[44:47], v[212:215]
    s_add_u32 s65, s65, 524288
    v_mfma_f32_16x16x32_bf16 v[244:247], v[20:23], v[48:51], v[244:247]
    v_mfma_f32_16x16x32_bf16 v[120:123], v[24:27], v[32:35], v[120:123]
    ds_read_b64_tr_b16 v[20:21], v86 offset:17416
    v_mfma_f32_16x16x32_bf16 v[152:155], v[24:27], v[36:39], v[152:155]
    ds_read_b64_tr_b16 v[22:23], v86 offset:17672
    v_mfma_f32_16x16x32_bf16 v[184:187], v[24:27], v[40:43], v[184:187]
    v_mfma_f32_16x16x32_bf16 v[216:219], v[24:27], v[44:47], v[216:219]
    v_mfma_f32_16x16x32_bf16 v[248:251], v[24:27], v[48:51], v[248:251]
    s_waitcnt lgkmcnt(2)
    v_mfma_f32_16x16x32_bf16 v[124:127], v[28:31], v[32:35], v[124:127]
    ds_read_b64_tr_b16 v[24:25], v86 offset:17920
    v_mfma_f32_16x16x32_bf16 v[156:159], v[28:31], v[36:39], v[156:159]
    ds_read_b64_tr_b16 v[26:27], v86 offset:18176
    v_mfma_f32_16x16x32_bf16 v[188:191], v[28:31], v[40:43], v[188:191]
    v_mfma_f32_16x16x32_bf16 v[220:223], v[28:31], v[44:47], v[220:223]
    v_mfma_f32_16x16x32_bf16 v[252:255], v[28:31], v[48:51], v[252:255]
    ds_read_b64_tr_b16 v[28:29], v86 offset:17928
    ds_read_b64_tr_b16 v[30:31], v86 offset:18184
    s_mov_b32 s60, 3
    s_mov_b32 s63, 0
L_q2:
    s_waitcnt lgkmcnt(2)
    v_mfma_f32_16x16x32_bf16 v[96:99], v[0:3], v[52:55], v[96:99]
    v_mfma_f32_16x16x32_bf16 v[128:131], v[0:3], v[56:59], v[128:131]
    v_mfma_f32_16x16x32_bf16 v[160:163], v[0:3], v[60:63], v[160:163]
    v_mfma_f32_16x16x32_bf16 v[192:195], v[0:3], v[64:67], v[192:195]
    v_mfma_f32_16x16x32_bf16 v[224:227], v[0:3], v[68:71], v[224:227]
    s_waitcnt vmcnt(8) lgkmcnt(0)
    s_barrier
    v_add_u32 v86, s42, v88
    v_add_u32 v85, s42, v87
    v_mfma_f32_16x16x32_bf16 v[100:103], v[4:7], v[52:55], v[100:103]
    ds_read_b64_tr_b16 v[0:1], v86 offset:0
    ds_read_b64_tr_b16 v[2:3], v86 offset:256
    v_mfma_f32_16x16x32_bf16 v[132:135], v[4:7], v[56:59], v[132:135]
    s_mov_b32 s67, s66
    s_mov_b32 s66, s42
    v_mfma_f32_16x16x32_bf16 v[164:167], v[4:7], v[60:63], v[164:167]
    ds_read_b128 v[32:35], v85 offset:0
    s_lshl_b32 s62, s63, 1
    v_mfma_f32_16x16x32_bf16 v[196:199], v[4:7], v[64:67], v[196:199]
    ds_read_b128 v[36:39], v85 offset:2048
    s_add_u32 s62, s62, s73
    v_mfma_f32_16x16x32_bf16 v[228:231], v[4:7], v[68:71], v[228:231]
    ds_read_b128 v[40:43], v85 offset:4096
    s_mov_b32 m0, s62
    v_mfma_f32_16x16x32_bf16 v[104:107], v[8:11], v[52:55], v[104:107]
    ds_read_b64_tr_b16 v[4:5], v86 offset:8
    ds_read_b128 v[44:47], v85 offset:6144
    v_mfma_f32_16x16x32_bf16 v[136:139], v[8:11], v[56:59], v[136:139]
    ds_read_b64_tr_b16 v[6:7], v86 offset:264
    ds_read_b128 v[48:51], v85 offset:8192
    v_mfma_f32_16x16x32_bf16 v[168:171], v[8:11], v[60:63], v[168:171]
    s_nop 0
    buffer_load_dwordx4 v83, s[12:15], s63 offen nt lds
    v_mfma_f32_16x16x32_bf16 v[200:203], v[8:11], v[64:67], v[200:203]
    v_mfma_f32_16x16x32_bf16 v[232:235], v[8:11], v[68:71], v[232:235]
    buffer_load_dwordx4 v83, s[12:15], s63 offen offset:2048 nt lds
    v_mfma_f32_16x16x32_bf16 v[108:111], v[12:15], v[52:55], v[108:111]
    ds_read_b64_tr_b16 v[8:9], v86 offset:512
    v_mfma_f32_16x16x32_bf16 v[140:143], v[12:15], v[56:59], v[140:143]
    ds_read_b64_tr_b16 v[10:11], v86 offset:768
    v_mfma_f32_16x16x32_bf16 v[172:175], v[12:15], v[60:63], v[172:175]
    v_mfma_f32_16x16x32_bf16 v[204:207], v[12:15], v[64:67], v[204:207]
    v_mfma_f32_16x16x32_bf16 v[236:239], v[12:15], v[68:71], v[236:239]
    v_mfma_f32_16x16x32_bf16 v[112:115], v[16:19], v[52:55], v[112:115]
    ds_read_b64_tr_b16 v[12:13], v86 offset:520
    v_mfma_f32_16x16x32_bf16 v[144:147], v[16:19], v[56:59], v[144:147]
    ds_read_b64_tr_b16 v[14:15], v86 offset:776
    s_add_u32 m0, s62, 8192
    v_mfma_f32_16x16x32_bf16 v[176:179], v[16:19], v[60:63], v[176:179]
    s_nop 0
    buffer_load_dwordx4 v83, s[16:19], s63 offen nt lds
    v_mfma_f32_16x16x32_bf16 v[208:211], v[16:19], v[64:67], v[208:211]
    v_mfma_f32_16x16x32_bf16 v[240:243], v[16:19], v[68:71], v[240:243]
    v_mfma_f32_16x16x32_bf16 v[116:119], v[20:23], v[52:55], v[116:119]
    ds_read_b64_tr_b16 v[16:17], v86 offset:1024
    v_mfma_f32_16x16x32_bf16 v[148:151], v[20:23], v[56:59], v[148:151]
    ds_read_b64_tr_b16 v[18:19], v86 offset:1280
    v_mfma_f32_16x16x32_bf16 v[180:183], v[20:23], v[60:63], v[180:183]
    v_mfma_f32_16x16x32_bf16 v[212:215], v[20:23], v[64:67], v[212:215]
    buffer_load_dwordx4 v83, s[16:19], s63 offen offset:2048 nt lds
    s_add_u32 s63, s63, 8192
    v_mfma_f32_16x16x32_bf16 v[244:247], v[20:23], v[68:71], v[244:247]
    v_mfma_f32_16x16x32_bf16 v[120:123], v[24:27], v[52:55], v[120:123]
    ds_read_b64_tr_b16 v[20:21], v86 offset:1032
    v_mfma_f32_16x16x32_bf16 v[152:155], v[24:27], v[56:59], v[152:155]
    ds_read_b64_tr_b16 v[22:23], v86 offset:1288
    v_mfma_f32_16x16x32_bf16 v[184:187], v[24:27], v[60:63], v[184:187]
    v_mfma_f32_16x16x32_bf16 v[216:219], v[24:27], v[64:67], v[216:219]
    v_mfma_f32_16x16x32_bf16 v[248:251], v[24:27], v[68:71], v[248:251]
    v_mfma_f32_16x16x32_bf16 v[124:127], v[28:31], v[52:55], v[124:127]
    ds_read_b64_tr_b16 v[24:25], v86 offset:1536
    v_mfma_f32_16x16x32_bf16 v[156:159], v[28:31], v[56:59], v[156:159]
    ds_read_b64_tr_b16 v[26:27], v86 offset:1792
    v_mfma_f32_16x16x32_bf16 v[188:191], v[28:31], v[60:63], v[188:191]
    v_mfma_f32_16x16x32_bf16 v[220:223], v[28:31], v[64:67], v[220:223]
    v_mfma_f32_16x16x32_bf16 v[252:255], v[28:31], v[68:71], v[252:255]
    ds_read_b64_tr_b16 v[28:29], v86 offset:1544
    ds_read_b64_tr_b16 v[30:31], v86 offset:1800
    s_sub_u32 s60, s60, 1
    s_cmp_eq_u32 s60, 0
    s_cbranch_scc1 L_q2_done
    s_waitcnt lgkmcnt(2)
    v_mfma_f32_16x16x32_bf16 v[96:99], v[0:3], v[32:35], v[96:99]
    ds_read_b128 v[52:55], v85 offset:512
    s_add_u32 s42, s66, 53248
    v_mfma_f32_16x16x32_bf16 v[128:131], v[0:3], v[36:39], v[128:131]
    ds_read_b128 v[56:59], v85 offset:2560
    v_mfma_f32_16x16x32_bf16 v[160:163], v[0:3], v[40:43], v[160:163]
    ds_read_b128 v[60:63], v85 offset:4608
    v_mfma_f32_16x16x32_bf16 v[192:195], v[0:3], v[44:47], v[192:195]
    ds_read_b128 v[64:67], v85 offset:6656
    s_lshl_b32 s62, s63, 1
    v_mfma_f32_16x16x32_bf16 v[224:227], v[0:3], v[48:51], v[224:227]
    ds_read_b128 v[68:71], v85 offset:8704
    s_add_u32 s62, s62, s73
    v_mfma_f32_16x16x32_bf16 v[100:103], v[4:7], v[32:35], v[100:103]
    ds_read_b64_tr_b16 v[0:1], v86 offset:16384
    s_mov_b32 m0, s62
    v_mfma_f32_16x16x32_bf16 v[132:135], v[4:7], v[36:39], v[132:135]
    ds_read_b64_tr_b16 v[2:3], v86 offset:16640
    s_nop 0
    v_mfma_f32_16x16x32_bf16 v[164:167], v[4:7], v[40:43], v[164:167]
    s_cmp_eq_u32 s42, 163840
    s_cselect_b32 s42, 4096, s42
    v_mfma_f32_16x16x32_bf16 v[196:199], v[4:7], v[44:47], v[196:199]
    buffer_load_dwordx4 v83, s[12:15], s63 offen nt lds
    v_mfma_f32_16x16x32_bf16 v[228:231], v[4:7], v[48:51], v[228:231]
    buffer_load_dwordx4 v83, s[12:15], s63 offen offset:2048 nt lds
    v_mfma_f32_16x16x32_bf16 v[104:107], v[8:11], v[32:35], v[104:107]
    ds_read_b64_tr_b16 v[4:5], v86 offset:16392
    v_mfma_f32_16x16x32_bf16 v[136:139], v[8:11], v[36:39], v[136:139]
    ds_read_b64_tr_b16 v[6:7], v86 offset:16648
    v_mfma_f32_16x16x32_bf16 v[168:171], v[8:11], v[40:43], v[168:171]
    v_mfma_f32_16x16x32_bf16 v[200:203], v[8:11], v[44:47], v[200:203]
    v_mfma_f32_16x16x32_bf16 v[232:235], v[8:11], v[48:51], v[232:235]
    v_mfma_f32_16x16x32_bf16 v[108:111], v[12:15], v[32:35], v[108:111]
    ds_read_b64_tr_b16 v[8:9], v86 offset:16896
    v_mfma_f32_16x16x32_bf16 v[140:143], v[12:15], v[36:39], v[140:143]
    ds_read_b64_tr_b16 v[10:11], v86 offset:17152
    s_add_u32 m0, s62, 8192
    v_mfma_f32_16x16x32_bf16 v[172:175], v[12:15], v[40:43], v[172:175]
    s_nop 0
    buffer_load_dwordx4 v83, s[16:19], s63 offen nt lds
    v_mfma_f32_16x16x32_bf16 v[204:207], v[12:15], v[44:47], v[204:207]
    v_mfma_f32_16x16x32_bf16 v[236:239], v[12:15], v[48:51], v[236:239]
    v_mfma_f32_16x16x32_bf16 v[112:115], v[16:19], v[32:35], v[112:115]
    ds_read_b64_tr_b16 v[12:13], v86 offset:16904
    v_mfma_f32_16x16x32_bf16 v[144:147], v[16:19], v[36:39], v[144:147]
    ds_read_b64_tr_b16 v[14:15], v86 offset:17160
    v_mfma_f32_16x16x32_bf16 v[176:179], v[16:19], v[40:43], v[176:179]
    v_mfma_f32_16x16x32_bf16 v[208:211], v[16:19], v[44:47], v[208:211]
    buffer_load_dwordx4 v83, s[16:19], s63 offen offset:2048 nt lds
    s_add_u32 s63, s63, 8192
    v_mfma_f32_16x16x32_bf16 v[240:243], v[16:19], v[48:51], v[240:243]
    v_mfma_f32_16x16x32_bf16 v[116:119], v[20:23], v[32:35], v[116:119]
    ds_read_b64_tr_b16 v[16:17], v86 offset:17408
    v_mfma_f32_16x16x32_bf16 v[148:151], v[20:23], v[36:39], v[148:151]
    ds_read_b64_tr_b16 v[18:19], v86 offset:17664
    v_mfma_f32_16x16x32_bf16 v[180:183], v[20:23], v[40:43], v[180:183]
    v_mfma_f32_16x16x32_bf16 v[212:215], v[20:23], v[44:47], v[212:215]
    v_mfma_f32_16x16x32_bf16 v[244:247], v[20:23], v[48:51], v[244:247]
    v_mfma_f32_16x16x32_bf16 v[120:123], v[24:27], v[32:35], v[120:123]
    ds_read_b64_tr_b16 v[20:21], v86 offset:17416
    v_mfma_f32_16x16x32_bf16 v[152:155], v[24:27], v[36:39], v[152:155]
    ds_read_b64_tr_b16 v[22:23], v86 offset:17672
    v_mfma_f32_16x16x32_bf16 v[184:187], v[24:27], v[40:43], v[184:187]
    v_mfma_f32_16x16x32_bf16 v[216:219], v[24:27], v[44:47], v[216:219]
    v_mfma_f32_16x16x32_bf16 v[248:251], v[24:27], v[48:51], v[248:251]
    s_waitcnt lgkmcnt(2)
    v_mfma_f32_16x16x32_bf16 v[124:127], v[28:31], v[32:35], v[124:127]
    ds_read_b64_tr_b16 v[24:25], v86 offset:17920
    v_mfma_f32_16x16x32_bf16 v[156:159], v[28:31], v[36:39], v[156:159]
    ds_read_b64_tr_b16 v[26:27], v86 offset:18176
    v_mfma_f32_16x16x32_bf16 v[188:191], v[28:31], v[40:43], v[188:191]
    v_mfma_f32_16x16x32_bf16 v[220:223], v[28:31], v[44:47], v[220:223]
    v_mfma_f32_16x16x32_bf16 v[252:255], v[28:31], v[48:51], v[252:255]
    ds_read_b64_tr_b16 v[28:29], v86 offset:17928
    ds_read_b64_tr_b16 v[30:31], v86 offset:18184
    s_branch L_q2
L_q2_done:
L_cv:
    s_lshl_b32 s62, s63, 1
    s_add_u32 s62, s62, s73
    s_mov_b32 m0, s62
    s_nop 0
    buffer_load_dwordx4 v83, s[12:15], s63 offen nt lds
    buffer_load_dwordx4 v83, s[12:15], s63 offen offset:2048 nt lds
    s_add_u32 s63, s63, 8192
    s_waitcnt vmcnt(16) lgkmcnt(0)
    s_barrier
    ds_read_b128 a[160:163], v81 offset:0
    ds_read_b128 a[164:167], v81 offset:512
    ds_read_b128 a[168:171], v81 offset:1024
    ds_read_b128 a[172:175], v81 offset:1536
    ds_read_b128 a[176:179], v81 offset:4096
    ds_read_b128 a[180:183], v81 offset:4608
    ds_read_b128 a[184:187], v81 offset:5120
    ds_read_b128 a[188:191], v81 offset:5632
    v_pk_mul_f32 v[96:97], v[96:97], v[92:93]
    v_pk_mul_f32 v[98:99], v[98:99], v[92:93]
    v_pk_mul_f32 v[100:101], v[100:101], v[92:93]
    v_pk_mul_f32 v[102:103], v[102:103], v[92:93]
    v_cvt_pk_bf16_f32 v96, v96, v97
    v_cvt_pk_bf16_f32 v97, v98, v99
    v_cvt_pk_bf16_f32 v98, v100, v101
    v_cvt_pk_bf16_f32 v99, v102, v103
    v_pk_mul_f32 v[104:105], v[104:105], v[92:93]
    v_pk_mul_f32 v[106:107], v[106:107], v[92:93]
    v_pk_mul_f32 v[108:109], v[108:109], v[92:93]
    v_pk_mul_f32 v[110:111], v[110:111], v[92:93]
    v_cvt_pk_bf16_f32 v100, v104, v105
    v_cvt_pk_bf16_f32 v101, v106, v107
    v_cvt_pk_bf16_f32 v102, v108, v109
    v_cvt_pk_bf16_f32 v103, v110, v111
    v_pk_mul_f32 v[112:113], v[112:113], v[92:93]
    v_pk_mul_f32 v[114:115], v[114:115], v[92:93]
    v_pk_mul_f32 v[116:117], v[116:117], v[92:93]
    v_pk_mul_f32 v[118:119], v[118:119], v[92:93]
    v_cvt_pk_bf16_f32 v104, v112, v113
    v_cvt_pk_bf16_f32 v105, v114, v115
    v_cvt_pk_bf16_f32 v106, v116, v117
    v_cvt_pk_bf16_f32 v107, v118, v119
    v_pk_mul_f32 v[120:121], v[120:121], v[92:93]
    v_pk_mul_f32 v[122:123], v[122:123], v[92:93]
    v_pk_mul_f32 v[124:125], v[124:125], v[92:93]
    v_pk_mul_f32 v[126:127], v[126:127], v[92:93]
    v_cvt_pk_bf16_f32 v108, v120, v121
    v_cvt_pk_bf16_f32 v109, v122, v123
    v_cvt_pk_bf16_f32 v110, v124, v125
    v_cvt_pk_bf16_f32 v111, v126, v127
    s_waitcnt lgkmcnt(0)
    v_mfma_f32_16x16x32_bf16 v[0:3], a[160:163], v[96:99], 0
    v_mul_f32 v128, v92, v128
    v_mul_f32 v129, v92, v129
    v_mul_f32 v130, v92, v130
    v_mul_f32 v131, v92, v131
    v_mul_f32 v132, v92, v132
    v_mul_f32 v133, v92, v133
    v_mfma_f32_16x16x32_bf16 v[0:3], a[164:167], v[100:103], v[0:3]
    v_mul_f32 v134, v92, v134
    v_mul_f32 v135, v92, v135
    v_cvt_pk_bf16_f32 v112, v128, v129
    v_cvt_pk_bf16_f32 v113, v130, v131
    v_cvt_pk_bf16_f32 v114, v132, v133
    v_cvt_pk_bf16_f32 v115, v134, v135
    v_mfma_f32_16x16x32_bf16 v[0:3], a[168:171], v[104:107], v[0:3]
    v_mul_f32 v136, v92, v136
    v_mul_f32 v137, v92, v137
    v_mul_f32 v138, v92, v138
    v_mul_f32 v139, v92, v139
    v_mul_f32 v140, v92, v140
    v_mul_f32 v141, v92, v141
    v_mfma_f32_16x16x32_bf16 v[0:3], a[172:175], v[108:111], v[0:3]
    v_mul_f32 v142, v92, v142
    v_mul_f32 v143, v92, v143
    v_cvt_pk_bf16_f32 v116, v136, v137
    v_cvt_pk_bf16_f32 v117, v138, v139
    v_cvt_pk_bf16_f32 v118, v140, v141
    v_cvt_pk_bf16_f32 v119, v142, v143
    v_mfma_f32_16x16x32_bf16 v[20:23], a[176:179], v[96:99], 0
    v_mul_f32 v144, v92, v144
    v_mul_f32 v145, v92, v145
    v_mul_f32 v146, v92, v146
    v_mul_f32 v147, v92, v147
    v_mul_f32 v148, v92, v148
    v_mul_f32 v149, v92, v149
    v_mfma_f32_16x16x32_bf16 v[20:23], a[180:183], v[100:103], v[20:23]
    v_mul_f32 v150, v92, v150
    v_mul_f32 v151, v92, v151
    v_cvt_pk_bf16_f32 v120, v144, v145
    v_cvt_pk_bf16_f32 v121, v146, v147
    v_cvt_pk_bf16_f32 v122, v148, v149
    v_cvt_pk_bf16_f32 v123, v150, v151
    v_mfma_f32_16x16x32_bf16 v[20:23], a[184:187], v[104:107], v[20:23]
    v_mul_f32 v152, v92, v152
    v_mul_f32 v153, v92, v153
    v_mul_f32 v154, v92, v154
    v_mul_f32 v155, v92, v155
    v_mul_f32 v156, v92, v156
    v_mul_f32 v157, v92, v157
    v_mfma_f32_16x16x32_bf16 v[20:23], a[188:191], v[108:111], v[20:23]
    v_mul_f32 v158, v92, v158
    v_mul_f32 v159, v92, v159
    v_cvt_pk_bf16_f32 v124, v152, v153
    v_cvt_pk_bf16_f32 v125, v154, v155
    v_cvt_pk_bf16_f32 v126, v156, v157
    v_cvt_pk_bf16_f32 v127, v158, v159
    v_mfma_f32_16x16x32_bf16 v[4:7], a[160:163], v[112:115], 0
    v_mul_f32 v160, v92, v160
    v_mul_f32 v161, v92, v161
    v_mul_f32 v162, v92, v162
    v_mul_f32 v163, v92, v163
    v_mul_f32 v164, v92, v164
    v_mul_f32 v165, v92, v165
    v_mfma_f32_16x16x32_bf16 v[4:7], a[164:167], v[116:119], v[4:7]
    v_mul_f32 v166, v92, v166
    v_mul_f32 v167, v92, v167
    v_cvt_pk_bf16_f32 v128, v160, v161
    v_cvt_pk_bf16_f32 v129, v162, v163
    v_cvt_pk_bf16_f32 v130, v164, v165
    v_cvt_pk_bf16_f32 v131, v166, v167
    v_mfma_f32_16x16x32_bf16 v[4:7], a[168:171], v[120:123], v[4:7]
    v_mul_f32 v168, v92, v168
    v_mul_f32 v169, v92, v169
    v_mul_f32 v170, v92, v170
    v_mul_f32 v171, v92, v171
    v_mul_f32 v172, v92, v172
    v_mul_f32 v173, v92, v173
    v_mfma_f32_16x16x32_bf16 v[4:7], a[172:175], v[124:127], v[4:7]
    v_mul_f32 v174, v92, v174
    v_mul_f32 v175, v92, v175
    v_cvt_pk_bf16_f32 v132, v168, v169
    v_cvt_pk_bf16_f32 v133, v170, v171
    v_cvt_pk_bf16_f32 v134, v172, v173
    v_cvt_pk_bf16_f32 v135, v174, v175
    v_mfma_f32_16x16x32_bf16 v[24:27], a[176:179], v[112:115], 0
    v_mul_f32 v176, v92, v176
    v_mul_f32 v177, v92, v177
    v_mul_f32 v178, v92, v178
    v_mul_f32 v179, v92, v179
    v_mul_f32 v180, v92, v180
    v_mul_f32 v181, v92, v181
    v_mfma_f32_16x16x32_bf16 v[24:27], a[180:183], v[116:119], v[24:27]
    v_mul_f32 v182, v92, v182
    v_mul_f32 v183, v92, v183
    v_cvt_pk_bf16_f32 v136, v176, v177
    v_cvt_pk_bf16_f32 v137, v178, v179
    v_cvt_pk_bf16_f32 v138, v180, v181
    v_cvt_pk_bf16_f32 v139, v182, v183
    v_mfma_f32_16x16x32_bf16 v[24:27], a[184:187], v[120:123], v[24:27]
    v_mul_f32 v184, v92, v184
    v_mul_f32 v185, v92, v185
    v_mul_f32 v186, v92, v186
    v_mul_f32 v187, v92, v187
    v_mul_f32 v188, v92, v188
    v_mul_f32 v189, v92, v189
    v_mfma_f32_16x16x32_bf16 v[24:27], a[188:191], v[124:127], v[24:27]
    v_mul_f32 v190, v92, v190
    v_mul_f32 v191, v92, v191
    v_cvt_pk_bf16_f32 v140, v184, v185
    v_cvt_pk_bf16_f32 v141, v186, v187
    v_cvt_pk_bf16_f32 v142, v188, v189
    v_cvt_pk_bf16_f32 v143, v190, v191
    v_mfma_f32_16x16x32_bf16 v[8:11], a[160:163], v[128:131], 0
    v_mul_f32 v192, v92, v192
    v_mul_f32 v193, v92, v193
    v_mul_f32 v194, v92, v194
    v_mul_f32 v195, v92, v195
    v_mul_f32 v196, v92, v196
    v_mul_f32 v197, v92, v197
    v_mfma_f32_16x16x32_bf16 v[8:11], a[164:167], v[132:135], v[8:11]
    v_mul_f32 v198, v92, v198
    v_mul_f32 v199, v92, v199
    v_cvt_pk_bf16_f32 v144, v192, v193
    v_cvt_pk_bf16_f32 v145, v194, v195
    v_cvt_pk_bf16_f32 v146, v196, v197
    v_cvt_pk_bf16_f32 v147, v198, v199
    v_mfma_f32_16x16x32_bf16 v[8:11], a[168:171], v[136:139], v[8:11]
    v_mul_f32 v200, v92, v200
    v_mul_f32 v201, v92, v201
    v_mul_f32 v202, v92, v202
    v_mul_f32 v203, v92, v203
    v_mul_f32 v204, v92, v204
    v_mul_f32 v205, v92, v205
    v_mfma_f32_16x16x32_bf16 v[8:11], a[172:175], v[140:143], v[8:11]
    v_mul_f32 v206, v92, v206
    v_mul_f32 v207, v92, v207
    v_cvt_pk_bf16_f32 v148, v200, v201
    v_cvt_pk_bf16_f32 v149, v202, v203
    v_cvt_pk_bf16_f32 v150, v204, v205
    v_cvt_pk_bf16_f32 v151, v206, v207
    v_mfma_f32_16x16x32_bf16 v[28:31], a[176:179], v[128:131], 0
    v_mul_f32 v208, v92, v208
    v_mul_f32 v209, v92, v209
    v_mul_f32 v210, v92, v210
    v_mul_f32 v211, v92, v211
    v_mul_f32 v212, v92, v212
    v_mul_f32 v213, v92, v213
    v_mfma_f32_16x16x32_bf16 v[28:31], a[180:183], v[132:135], v[28:31]
    v_mul_f32 v214, v92, v214
    v_mul_f32 v215, v92, v215
    v_cvt_pk_bf16_f32 v152, v208, v209
    v_cvt_pk_bf16_f32 v153, v210, v211
    v_cvt_pk_bf16_f32 v154, v212, v213
    v_cvt_pk_bf16_f32 v155, v214, v215
    v_mfma_f32_16x16x32_bf16 v[28:31], a[184:187], v[136:139], v[28:31]
    v_mul_f32 v216, v92, v216
    v_mul_f32 v217, v92, v217
    v_mul_f32 v218, v92, v218
    v_mul_f32 v219, v92, v219
    v_mul_f32 v220, v92, v220
    v_mul_f32 v221, v92, v221
    v_mfma_f32_16x16x32_bf16 v[28:31], a[188:191], v[140:143], v[28:31]
    v_mul_f32 v222, v92, v222
    v_mul_f32 v223, v92, v223
    v_cvt_pk_bf16_f32 v156, v216, v217
    v_cvt_pk_bf16_f32 v157, v218, v219
    v_cvt_pk_bf16_f32 v158, v220, v221
    v_cvt_pk_bf16_f32 v159, v222, v223
    v_mfma_f32_16x16x32_bf16 v[12:15], a[160:163], v[144:147], 0
    v_mul_f32 v224, v92, v224
    v_mul_f32 v225, v92, v225
    v_mul_f32 v226, v92, v226
    v_mul_f32 v227, v92, v227
    v_mul_f32 v228, v92, v228
    v_mul_f32 v229, v92, v229
    v_mfma_f32_16x16x32_bf16 v[12:15], a[164:167], v[148:151], v[12:15]
    v_mul_f32 v230, v92, v230
    v_mul_f32 v231, v92, v231
    v_cvt_pk_bf16_f32 v160, v224, v225
    v_cvt_pk_bf16_f32 v161, v226, v227
    v_cvt_pk_bf16_f32 v162, v228, v229
    v_cvt_pk_bf16_f32 v163, v230, v231
    v_mfma_f32_16x16x32_bf16 v[12:15], a[168:171], v[152:155], v[12:15]
    v_mul_f32 v232, v92, v232
    v_mul_f32 v233, v92, v233
    v_mul_f32 v234, v92, v234
    v_mul_f32 v235, v92, v235
    v_mul_f32 v236, v92, v236
    v_mul_f32 v237, v92, v237
    v_mfma_f32_16x16x32_bf16 v[12:15], a[172:175], v[156:159], v[12:15]
    v_mul_f32 v238, v92, v238
    v_mul_f32 v239, v92, v239
    v_cvt_pk_bf16_f32 v164, v232, v233
    v_cvt_pk_bf16_f32 v165, v234, v235
    v_cvt_pk_bf16_f32 v166, v236, v237
    v_cvt_pk_bf16_f32 v167, v238, v239
    v_mfma_f32_16x16x32_bf16 v[32:35], a[176:179], v[144:147], 0
    v_mul_f32 v240, v92, v240
    v_mul_f32 v241, v92, v241
    v_mul_f32 v242, v92, v242
    v_mul_f32 v243, v92, v243
    v_mul_f32 v244, v92, v244
    v_mul_f32 v245, v92, v245
    v_mfma_f32_16x16x32_bf16 v[32:35], a[180:183], v[148:151], v[32:35]
    v_mul_f32 v246, v92, v246
    v_mul_f32 v247, v92, v247
    v_cvt_pk_bf16_f32 v168, v240, v241
    v_cvt_pk_bf16_f32 v169, v242, v243
    v_cvt_pk_bf16_f32 v170, v244, v245
    v_cvt_pk_bf16_f32 v171, v246, v247
    v_mfma_f32_16x16x32_bf16 v[32:35], a[184:187], v[152:155], v[32:35]
    v_mul_f32 v248, v92, v248
    v_mul_f32 v249, v92, v249
    v_mul_f32 v250, v92, v250
    v_mul_f32 v251, v92, v251
    v_mul_f32 v252, v92, v252
    v_mul_f32 v253, v92, v253
    v_mfma_f32_16x16x32_bf16 v[32:35], a[188:191], v[156:159], v[32:35]
    v_mul_f32 v254, v92, v254
    v_mul_f32 v255, v92, v255
    v_cvt_pk_bf16_f32 v172, v248, v249
    v_cvt_pk_bf16_f32 v173, v250, v251
    v_cvt_pk_bf16_f32 v174, v252, v253
    v_cvt_pk_bf16_f32 v175, v254, v255
    s_nop 1
    v_mfma_f32_16x16x32_bf16 v[16:19], a[160:163], v[160:163], 0
    ds_read_b128 a[160:163], v81 offset:16384
    v_mfma_f32_16x16x32_bf16 v[16:19], a[164:167], v[164:167], v[16:19]
    ds_read_b128 a[164:167], v81 offset:16896
    v_mfma_f32_16x16x32_bf16 v[16:19], a[168:171], v[168:171], v[16:19]
    ds_read_b128 a[168:171], v81 offset:17408
    v_mfma_f32_16x16x32_bf16 v[16:19], a[172:175], v[172:175], v[16:19]
    ds_read_b128 a[172:175], v81 offset:17920
    v_mfma_f32_16x16x32_bf16 v[36:39], a[176:179], v[160:163], 0
    ds_read_b128 a[176:179], v81 offset:20480
    v_mfma_f32_16x16x32_bf16 v[36:39], a[180:183], v[164:167], v[36:39]
    ds_read_b128 a[180:183], v81 offset:20992
    v_mfma_f32_16x16x32_bf16 v[36:39], a[184:187], v[168:171], v[36:39]
    ds_read_b128 a[184:187], v81 offset:21504
    v_mfma_f32_16x16x32_bf16 v[36:39], a[188:191], v[172:175], v[36:39]
    ds_read_b128 a[188:191], v81 offset:22016
    s_nop 5
    v_max3_f32 v236, v0, v1, v2
    v_max3_f32 v236, v236, v3, v20
    v_max3_f32 v236, v236, v21, v22
    v_max_f32 v236, v236, v23
    v_max3_f32 v237, v4, v5, v6
    v_max3_f32 v237, v237, v7, v24
    v_max3_f32 v237, v237, v25, v26
    v_max_f32 v237, v237, v27
    v_max3_f32 v238, v8, v9, v10
    v_max3_f32 v238, v238, v11, v28
    v_max3_f32 v238, v238, v29, v30
    v_max_f32 v238, v238, v31
    v_max3_f32 v239, v12, v13, v14
    v_max3_f32 v239, v239, v15, v32
    v_max3_f32 v239, v239, v33, v34
    v_max_f32 v239, v239, v35
    v_max3_f32 v240, v16, v17, v18
    v_max3_f32 v240, v240, v19, v36
    v_max3_f32 v240, v240, v37, v38
    v_max_f32 v240, v240, v39
    v_mov_b32 v241, v236
    v_mov_b32 v242, v237
    v_mov_b32 v243, v238
    v_mov_b32 v244, v239
    v_mov_b32 v245, v240
    s_nop 1
    v_permlane32_swap_b32 v236, v241
    v_permlane32_swap_b32 v237, v242
    v_permlane32_swap_b32 v238, v243
    v_permlane32_swap_b32 v239, v244
    v_permlane32_swap_b32 v240, v245
    s_nop 1
    v_max_f32 v236, v236, v241
    v_max_f32 v237, v237, v242
    v_max_f32 v238, v238, v243
    v_max_f32 v239, v239, v244
    v_max_f32 v240, v240, v245
    v_mov_b32 v241, v236
    v_mov_b32 v242, v237
    v_mov_b32 v243, v238
    v_mov_b32 v244, v239
    v_mov_b32 v245, v240
    s_nop 1
    v_permlane16_swap_b32 v236, v241
    v_permlane16_swap_b32 v237, v242
    v_permlane16_swap_b32 v238, v243
    v_permlane16_swap_b32 v239, v244
    v_permlane16_swap_b32 v240, v245
    s_nop 1
    v_max_f32 v236, v236, v241
    v_max_f32 v237, v237, v242
    v_max_f32 v238, v238, v243
    v_max_f32 v239, v239, v244
    v_max_f32 v240, v240, v245
L_have_max:
    v_mov_b32 v196, 0
    v_mov_b32 v197, 0
    v_mov_b32 v198, 0
    v_mov_b32 v199, 0
    v_mov_b32 v200, 0
    v_mov_b32 v201, 0
    v_mov_b32 v202, 0
    v_mov_b32 v203, 0
    v_mov_b32 v204, 0
    v_mov_b32 v205, 0
    v_mov_b32 v206, 0
    v_mov_b32 v207, 0
    v_mov_b32 v208, 0
    v_mov_b32 v209, 0
    v_mov_b32 v210, 0
    v_mov_b32 v211, 0
    v_mov_b32 v212, 0
    v_mov_b32 v213, 0
    v_mov_b32 v214, 0
    v_mov_b32 v215, 0
    v_mov_b32 v91, 0
    v_mov_b32 v95, 0
    v_sub_f32 v216, 0, v236
    v_sub_f32 v217, 0, v236
    v_sub_f32 v218, 0, v236
    v_sub_f32 v219, 0, v236
    v_sub_f32 v220, 0, v237
    v_sub_f32 v221, 0, v237
    v_sub_f32 v222, 0, v237
    v_sub_f32 v223, 0, v237
    v_sub_f32 v224, 0, v238
    v_sub_f32 v225, 0, v238
    v_sub_f32 v226, 0, v238
    v_sub_f32 v227, 0, v238
    v_sub_f32 v228, 0, v239
    v_sub_f32 v229, 0, v239
    v_sub_f32 v230, 0, v239
    v_sub_f32 v231, 0, v239
    v_sub_f32 v232, 0, v240
    v_sub_f32 v233, 0, v240
    v_sub_f32 v234, 0, v240
    v_sub_f32 v235, 0, v240
    v_sub_f32 v0, v0, v236
    v_sub_f32 v1, v1, v236
    v_sub_f32 v2, v2, v236
    v_sub_f32 v3, v3, v236
    v_sub_f32 v4, v4, v237
    v_sub_f32 v5, v5, v237
    v_sub_f32 v6, v6, v237
    v_sub_f32 v7, v7, v237
    v_sub_f32 v8, v8, v238
    v_sub_f32 v9, v9, v238
    v_sub_f32 v10, v10, v238
    v_sub_f32 v11, v11, v238
    v_sub_f32 v12, v12, v239
    v_sub_f32 v13, v13, v239
    v_sub_f32 v14, v14, v239
    v_sub_f32 v15, v15, v239
    v_sub_f32 v16, v16, v240
    v_sub_f32 v17, v17, v240
    v_sub_f32 v18, v18, v240
    v_sub_f32 v19, v19, v240
    v_sub_f32 v20, v20, v236
    v_sub_f32 v21, v21, v236
    v_sub_f32 v22, v22, v236
    v_sub_f32 v23, v23, v236
    v_sub_f32 v24, v24, v237
    v_sub_f32 v25, v25, v237
    v_sub_f32 v26, v26, v237
    v_sub_f32 v27, v27, v237
    v_sub_f32 v28, v28, v238
    v_sub_f32 v29, v29, v238
    v_sub_f32 v30, v30, v238
    v_sub_f32 v31, v31, v238
    v_sub_f32 v32, v32, v239
    v_sub_f32 v33, v33, v239
    v_sub_f32 v34, v34, v239
    v_sub_f32 v35, v35, v239
    v_sub_f32 v36, v36, v240
    v_sub_f32 v37, v37, v240
    v_sub_f32 v38, v38, v240
    v_sub_f32 v39, v39, v240
    v_add_u32 v82, 0x1a000, v82
    s_mov_b32 s68, 49152
    s_mov_b32 s69, 32768
    s_add_u32 s70, s73, 98304
    s_add_u32 s71, s73, 40960
    s_mov_b32 s60, 15
    s_waitcnt lgkmcnt(0)
    v_exp_f32 v0, v0
    v_mfma_f32_16x16x32_bf16 v[40:43], a[160:163], v[96:99], v[216:219]
    v_exp_f32 v1, v1
    v_add_u32 v81, 0x8000, v81
    v_add_u32 v82, 0x8000, v82
    v_mfma_f32_16x16x32_bf16 v[44:47], a[160:163], v[112:115], v[220:223]
    v_exp_f32 v2, v2
    v_cvt_pk_bf16_f32 v176, v0, v1
    v_add_f32 v91, v91, v0
    v_mfma_f32_16x16x32_bf16 v[48:51], a[160:163], v[128:131], v[224:227]
    v_exp_f32 v3, v3
    v_and_b32 v81, 0x1ffff, v81
    v_and_b32 v82, 0x1ffff, v82
    v_mfma_f32_16x16x32_bf16 v[52:55], a[160:163], v[144:147], v[228:231]
    v_exp_f32 v4, v4
    v_cvt_pk_bf16_f32 v177, v2, v3
    s_waitcnt vmcnt(8) lgkmcnt(0)
    s_barrier
    v_mfma_f32_16x16x32_bf16 v[56:59], a[160:163], v[160:163], v[232:235]
    v_exp_f32 v5, v5
    ds_read_b128 a[160:163], v81 offset:0
    ds_read_b64_tr_b16 a[192:193], v82 offset:0
    v_mfma_f32_16x16x32_bf16 v[40:43], a[164:167], v[100:103], v[40:43]
    v_exp_f32 v6, v6
    v_cvt_pk_bf16_f32 v180, v4, v5
    v_add_f32 v91, v91, v1
    v_mfma_f32_16x16x32_bf16 v[44:47], a[164:167], v[116:119], v[44:47]
    v_exp_f32 v7, v7
    ds_read_b64_tr_b16 a[194:195], v82 offset:4096
    v_xor_b32 v84, 32, v82
    v_mfma_f32_16x16x32_bf16 v[48:51], a[164:167], v[132:135], v[48:51]
    v_exp_f32 v8, v8
    v_cvt_pk_bf16_f32 v181, v6, v7
    v_add_f32 v91, v91, v2
    s_mov_b32 m0, s70
    s_add_u32 s71, s71, 0x8000
    v_mfma_f32_16x16x32_bf16 v[52:55], a[164:167], v[148:151], v[52:55]
    v_exp_f32 v9, v9
    buffer_load_dwordx4 v83, s[12:15], s68 offen nt lds
    s_and_b32 s71, s71, 0x1ffff
    v_mfma_f32_16x16x32_bf16 v[56:59], a[164:167], v[164:167], v[56:59]
    v_exp_f32 v10, v10
    v_cvt_pk_bf16_f32 v184, v8, v9
    v_add_f32 v91, v91, v3
    v_mfma_f32_16x16x32_bf16 v[40:43], a[168:171], v[104:107], v[40:43]
    v_exp_f32 v11, v11
    ds_read_b128 a[164:167], v81 offset:512
    ds_read_b64_tr_b16 a[196:197], v84 offset:0
    v_mfma_f32_16x16x32_bf16 v[44:47], a[168:171], v[120:123], v[44:47]
    v_exp_f32 v12, v12
    v_cvt_pk_bf16_f32 v185, v10, v11
    v_add_f32 v95, v95, v4
    v_mfma_f32_16x16x32_bf16 v[48:51], a[168:171], v[136:139], v[48:51]
    v_exp_f32 v13, v13
    ds_read_b64_tr_b16 a[198:199], v84 offset:4096
    v_mfma_f32_16x16x32_bf16 v[52:55], a[168:171], v[152:155], v[52:55]
    v_exp_f32 v14, v14
    v_cvt_pk_bf16_f32 v188, v12, v13
    v_add_f32 v95, v95, v5
    v_mfma_f32_16x16x32_bf16 v[56:59], a[168:171], v[168:171], v[56:59]
    v_exp_f32 v15, v15
    ds_read_b128 a[168:171], v81 offset:1024
    ds_read_b64_tr_b16 a[200:201], v82 offset:512
    v_mfma_f32_16x16x32_bf16 v[40:43], a[172:175], v[108:111], v[40:43]
    v_exp_f32 v16, v16
    v_cvt_pk_bf16_f32 v189, v14, v15
    v_add_f32 v95, v95, v6
    v_mfma_f32_16x16x32_bf16 v[44:47], a[172:175], v[124:127], v[44:47]
    v_exp_f32 v17, v17
    ds_read_b64_tr_b16 a[202:203], v82 offset:4608
    s_waitcnt lgkmcnt(3)
    v_mfma_f32_16x16x32_bf16 v[48:51], a[172:175], v[140:143], v[48:51]
    v_exp_f32 v18, v18
    v_cvt_pk_bf16_f32 v192, v16, v17
    v_add_f32 v95, v95, v7
    v_mfma_f32_16x16x32_bf16 v[52:55], a[172:175], v[156:159], v[52:55]
    v_exp_f32 v19, v19
    buffer_load_dwordx4 v83, s[12:15], s68 offen offset:2048 nt lds
    v_mfma_f32_16x16x32_bf16 v[56:59], a[172:175], v[172:175], v[56:59]
    v_exp_f32 v20, v20
    v_cvt_pk_bf16_f32 v193, v18, v19
    v_mfma_f32_16x16x32_bf16 v[60:63], a[176:179], v[96:99], v[216:219]
    v_exp_f32 v21, v21
    ds_read_b128 a[172:175], v81 offset:1536
    ds_read_b64_tr_b16 a[204:205], v84 offset:512
    v_mfma_f32_16x16x32_bf16 v[64:67], a[176:179], v[112:115], v[220:223]
    v_exp_f32 v22, v22
    v_cvt_pk_bf16_f32 v178, v20, v21
    v_mfma_f32_16x16x32_bf16 v[68:71], a[176:179], v[128:131], v[224:227]
    v_exp_f32 v23, v23
    ds_read_b64_tr_b16 a[206:207], v84 offset:4608
    s_mov_b32 m0, s71
    v_mfma_f32_16x16x32_bf16 v[72:75], a[176:179], v[144:147], v[228:231]
    v_exp_f32 v24, v24
    v_cvt_pk_bf16_f32 v179, v22, v23
    v_add_f32 v91, v91, v20
    v_mfma_f32_16x16x32_bf16 v[76:79], a[176:179], v[160:163], v[232:235]
    v_exp_f32 v25, v25
    ds_read_b128 a[176:179], v81 offset:4096
    ds_read_b64_tr_b16 a[208:209], v82 offset:1024
    v_mfma_f32_16x16x32_bf16 v[60:63], a[180:183], v[100:103], v[60:63]
    v_exp_f32 v26, v26
    v_cvt_pk_bf16_f32 v182, v24, v25
    v_add_f32 v91, v91, v21
    v_mfma_f32_16x16x32_bf16 v[64:67], a[180:183], v[116:119], v[64:67]
    v_exp_f32 v27, v27
    ds_read_b64_tr_b16 a[210:211], v82 offset:5120
    v_mfma_f32_16x16x32_bf16 v[68:71], a[180:183], v[132:135], v[68:71]
    v_exp_f32 v28, v28
    v_cvt_pk_bf16_f32 v183, v26, v27
    v_add_f32 v91, v91, v22
    v_mfma_f32_16x16x32_bf16 v[72:75], a[180:183], v[148:151], v[72:75]
    v_exp_f32 v29, v29
    buffer_load_dwordx4 v83, s[16:19], s69 offen nt lds
    v_mfma_f32_16x16x32_bf16 v[76:79], a[180:183], v[164:167], v[76:79]
    v_exp_f32 v30, v30
    v_cvt_pk_bf16_f32 v186, v28, v29
    v_add_f32 v91, v91, v23
    v_mfma_f32_16x16x32_bf16 v[60:63], a[184:187], v[104:107], v[60:63]
    v_exp_f32 v31, v31
    ds_read_b128 a[180:183], v81 offset:4608
    ds_read_b64_tr_b16 a[212:213], v84 offset:1024
    v_mfma_f32_16x16x32_bf16 v[64:67], a[184:187], v[120:123], v[64:67]
    v_exp_f32 v32, v32
    v_cvt_pk_bf16_f32 v187, v30, v31
    v_add_f32 v95, v95, v24
    v_mfma_f32_16x16x32_bf16 v[68:71], a[184:187], v[136:139], v[68:71]
    v_exp_f32 v33, v33
    ds_read_b64_tr_b16 a[214:215], v84 offset:5120
    s_waitcnt lgkmcnt(3)
    v_mfma_f32_16x16x32_bf16 v[72:75], a[184:187], v[152:155], v[72:75]
    v_exp_f32 v34, v34
    v_cvt_pk_bf16_f32 v190, v32, v33
    v_add_f32 v95, v95, v25
    v_mfma_f32_16x16x32_bf16 v[76:79], a[184:187], v[168:171], v[76:79]
    v_exp_f32 v35, v35
    ds_read_b128 a[184:187], v81 offset:5120
    ds_read_b64_tr_b16 a[216:217], v82 offset:1536
    v_mfma_f32_16x16x32_bf16 v[60:63], a[188:191], v[108:111], v[60:63]
    v_exp_f32 v36, v36
    v_cvt_pk_bf16_f32 v191, v34, v35
    v_add_f32 v95, v95, v26
    v_mfma_f32_16x16x32_bf16 v[64:67], a[188:191], v[124:127], v[64:67]
    v_exp_f32 v37, v37
    ds_read_b64_tr_b16 a[218:219], v82 offset:5632
    v_mfma_f32_16x16x32_bf16 v[68:71], a[188:191], v[140:143], v[68:71]
    v_exp_f32 v38, v38
    v_cvt_pk_bf16_f32 v194, v36, v37
    v_add_f32 v95, v95, v27
    v_mfma_f32_16x16x32_bf16 v[72:75], a[188:191], v[156:159], v[72:75]
    v_exp_f32 v39, v39
    buffer_load_dwordx4 v83, s[16:19], s69 offen offset:2048 nt lds
    v_mfma_f32_16x16x32_bf16 v[76:79], a[188:191], v[172:175], v[76:79]
    s_nop 0
    v_cvt_pk_bf16_f32 v195, v38, v39
    ds_read_b128 a[188:191], v81 offset:5632
    ds_read_b64_tr_b16 a[220:221], v84 offset:1536
    ds_read_b64_tr_b16 a[222:223], v84 offset:5632
.p2align 3
L_loop:
    v_mfma_f32_16x16x32_bf16 v[0:3], a[160:163], v[96:99], v[216:219]
    v_exp_f32 v40, v40
    v_mfma_f32_16x16x32_bf16 a[0:3], a[192:195], v[176:179], a[0:3]
    s_cmp_eq_u32 s60, 1
    s_cbranch_scc1 L_wot
L_wot_back:
    v_mfma_f32_16x16x32_bf16 v[4:7], a[160:163], v[112:115], v[220:223]
    v_exp_f32 v41, v41
    v_mfma_f32_16x16x32_bf16 a[32:35], a[192:195], v[180:183], a[32:35]
    v_cvt_pk_bf16_f32 v196, v40, v41
    v_add_f32 v91, v91, v40
    v_mfma_f32_16x16x32_bf16 v[8:11], a[160:163], v[128:131], v[224:227]
    v_exp_f32 v42, v42
    v_mfma_f32_16x16x32_bf16 a[64:67], a[192:195], v[184:187], a[64:67]
    s_waitcnt lgkmcnt(3)
    v_mfma_f32_16x16x32_bf16 v[12:15], a[160:163], v[144:147], v[228:231]
    v_exp_f32 v43, v43
    v_mfma_f32_16x16x32_bf16 a[96:99], a[192:195], v[188:191], a[96:99]
    v_cvt_pk_bf16_f32 v197, v42, v43
    v_mfma_f32_16x16x32_bf16 v[16:19], a[160:163], v[160:163], v[232:235]
    v_exp_f32 v44, v44
    v_mfma_f32_16x16x32_bf16 a[128:131], a[192:195], v[192:195], a[128:131]
    ds_read_b128 a[160:163], v81 offset:16384
    ds_read_b64_tr_b16 a[192:193], v82 offset:16384
    v_mfma_f32_16x16x32_bf16 v[0:3], a[164:167], v[100:103], v[0:3]
    v_exp_f32 v45, v45
    v_mfma_f32_16x16x32_bf16 a[4:7], a[196:199], v[176:179], a[4:7]
    v_cvt_pk_bf16_f32 v200, v44, v45
    v_add_f32 v91, v91, v41
    v_mfma_f32_16x16x32_bf16 v[4:7], a[164:167], v[116:119], v[4:7]
    v_exp_f32 v46, v46
    v_mfma_f32_16x16x32_bf16 a[36:39], a[196:199], v[180:183], a[36:39]
    ds_read_b64_tr_b16 a[194:195], v82 offset:20480
    v_mfma_f32_16x16x32_bf16 v[8:11], a[164:167], v[132:135], v[8:11]
    v_exp_f32 v47, v47
    v_mfma_f32_16x16x32_bf16 a[68:71], a[196:199], v[184:187], a[68:71]
    v_cvt_pk_bf16_f32 v201, v46, v47
    v_add_f32 v91, v91, v42
    v_mfma_f32_16x16x32_bf16 a[232:235], a[244:247], v[184:187], a[232:235]
    s_add_u32 m0, s70, 16384
    s_add_u32 s61, s68, 8192
    v_mfma_f32_16x16x32_bf16 v[12:15], a[164:167], v[148:151], v[12:15]
    v_exp_f32 v48, v48
    v_mfma_f32_16x16x32_bf16 a[100:103], a[196:199], v[188:191], a[100:103]
    buffer_load_dwordx4 v83, s[12:15], s61 offen nt lds
    v_mfma_f32_16x16x32_bf16 v[16:19], a[164:167], v[164:167], v[16:19]
    v_exp_f32 v49, v49
    v_mfma_f32_16x16x32_bf16 a[132:135], a[196:199], v[192:195], a[132:135]
    v_cvt_pk_bf16_f32 v204, v48, v49
    v_add_f32 v91, v91, v43
    v_mfma_f32_16x16x32_bf16 v[0:3], a[168:171], v[104:107], v[0:3]
    v_exp_f32 v50, v50
    v_mfma_f32_16x16x32_bf16 a[8:11], a[200:203], v[176:179], a[8:11]
    ds_read_b128 a[164:167], v81 offset:16896
    ds_read_b64_tr_b16 a[196:197], v84 offset:16384
    v_mfma_f32_16x16x32_bf16 v[4:7], a[168:171], v[120:123], v[4:7]
    v_exp_f32 v51, v51
    v_mfma_f32_16x16x32_bf16 a[40:43], a[200:203], v[180:183], a[40:43]
    v_cvt_pk_bf16_f32 v205, v50, v51
    v_add_f32 v95, v95, v44
    v_mfma_f32_16x16x32_bf16 v[8:11], a[168:171], v[136:139], v[8:11]
    v_exp_f32 v52, v52
    v_mfma_f32_16x16x32_bf16 a[72:75], a[200:203], v[184:187], a[72:75]
    ds_read_b64_tr_b16 a[198:199], v84 offset:20480
    s_add_u32 s70, s70, 0x8000
    v_mfma_f32_16x16x32_bf16 v[12:15], a[168:171], v[152:155], v[12:15]
    v_exp_f32 v53, v53
    v_mfma_f32_16x16x32_bf16 a[104:107], a[200:203], v[188:191], a[104:107]
    v_cvt_pk_bf16_f32 v208, v52, v53
    v_add_f32 v95, v95, v45
    v_mfma_f32_16x16x32_bf16 v[16:19], a[168:171], v[168:171], v[16:19]
    v_exp_f32 v54, v54
    v_mfma_f32_16x16x32_bf16 a[136:139], a[200:203], v[192:195], a[136:139]
    ds_read_b128 a[168:171], v81 offset:17408
    ds_read_b64_tr_b16 a[200:201], v82 offset:16896
    v_mfma_f32_16x16x32_bf16 v[0:3], a[172:175], v[108:111], v[0:3]
    v_exp_f32 v55, v55
    v_mfma_f32_16x16x32_bf16 a[12:15], a[204:207], v[176:179], a[12:15]
    v_cvt_pk_bf16_f32 v209, v54, v55
    v_add_f32 v95, v95, v46
    v_mfma_f32_16x16x32_bf16 v[4:7], a[172:175], v[124:127], v[4:7]
    v_exp_f32 v56, v56
    v_mfma_f32_16x16x32_bf16 a[44:47], a[204:207], v[180:183], a[44:47]
    ds_read_b64_tr_b16 a[202:203], v82 offset:20992
    s_waitcnt lgkmcnt(3)
    v_mfma_f32_16x16x32_bf16 v[8:11], a[172:175], v[140:143], v[8:11]
    v_exp_f32 v57, v57
    v_mfma_f32_16x16x32_bf16 a[76:79], a[204:207], v[184:187], a[76:79]
    v_cvt_pk_bf16_f32 v212, v56, v57
    v_add_f32 v95, v95, v47
    v_mfma_f32_16x16x32_bf16 v[12:15], a[172:175], v[156:159], v[12:15]
    v_exp_f32 v58, v58
    v_mfma_f32_16x16x32_bf16 a[108:111], a[204:207], v[188:191], a[108:111]
    buffer_load_dwordx4 v83, s[12:15], s61 offen offset:2048 nt lds
    s_and_b32 s70, s70, 0x1ffff
    v_mfma_f32_16x16x32_bf16 v[16:19], a[172:175], v[172:175], v[16:19]
    v_exp_f32 v59, v59
    v_mfma_f32_16x16x32_bf16 a[140:143], a[204:207], v[192:195], a[140:143]
    v_cvt_pk_bf16_f32 v213, v58, v59
    v_mfma_f32_16x16x32_bf16 v[20:23], a[176:179], v[96:99], v[216:219]
    v_exp_f32 v60, v60
    v_mfma_f32_16x16x32_bf16 a[16:19], a[208:211], v[176:179], a[16:19]
    ds_read_b128 a[172:175], v81 offset:17920
    ds_read_b64_tr_b16 a[204:205], v84 offset:16896
    v_mfma_f32_16x16x32_bf16 v[24:27], a[176:179], v[112:115], v[220:223]
    v_exp_f32 v61, v61
    v_mfma_f32_16x16x32_bf16 a[48:51], a[208:211], v[180:183], a[48:51]
    v_cvt_pk_bf16_f32 v198, v60, v61
    v_mfma_f32_16x16x32_bf16 v[28:31], a[176:179], v[128:131], v[224:227]
    v_exp_f32 v62, v62
    v_mfma_f32_16x16x32_bf16 a[80:83], a[208:211], v[184:187], a[80:83]
    ds_read_b64_tr_b16 a[206:207], v84 offset:20992
    s_add_u32 m0, s71, 16384
    v_mfma_f32_16x16x32_bf16 v[32:35], a[176:179], v[144:147], v[228:231]
    v_exp_f32 v63, v63
    v_mfma_f32_16x16x32_bf16 a[112:115], a[208:211], v[188:191], a[112:115]
    v_cvt_pk_bf16_f32 v199, v62, v63
    v_add_f32 v91, v91, v60
    v_mfma_f32_16x16x32_bf16 a[236:239], a[244:247], v[188:191], a[236:239]
    s_add_u32 s62, s69, 8192
    v_mfma_f32_16x16x32_bf16 v[36:39], a[176:179], v[160:163], v[232:235]
    v_exp_f32 v64, v64
    v_mfma_f32_16x16x32_bf16 a[144:147], a[208:211], v[192:195], a[144:147]
    ds_read_b128 a[176:179], v81 offset:20480
    ds_read_b64_tr_b16 a[208:209], v82 offset:17408
    v_mfma_f32_16x16x32_bf16 v[20:23], a[180:183], v[100:103], v[20:23]
    v_exp_f32 v65, v65
    v_mfma_f32_16x16x32_bf16 a[20:23], a[212:215], v[176:179], a[20:23]
    v_cvt_pk_bf16_f32 v202, v64, v65
    v_add_f32 v91, v91, v61
    v_mfma_f32_16x16x32_bf16 v[24:27], a[180:183], v[116:119], v[24:27]
    v_exp_f32 v66, v66
    v_mfma_f32_16x16x32_bf16 a[52:55], a[212:215], v[180:183], a[52:55]
    ds_read_b64_tr_b16 a[210:211], v82 offset:21504
    s_add_u32 s68, s68, 16384
    v_mfma_f32_16x16x32_bf16 v[28:31], a[180:183], v[132:135], v[28:31]
    v_exp_f32 v67, v67
    v_mfma_f32_16x16x32_bf16 a[84:87], a[212:215], v[184:187], a[84:87]
    v_cvt_pk_bf16_f32 v203, v66, v67
    v_add_f32 v91, v91, v62
    v_mfma_f32_16x16x32_bf16 v[32:35], a[180:183], v[148:151], v[32:35]
    v_exp_f32 v68, v68
    v_mfma_f32_16x16x32_bf16 a[116:119], a[212:215], v[188:191], a[116:119]
    buffer_load_dwordx4 v83, s[16:19], s62 offen nt lds
    s_add_u32 s69, s69, 16384
    v_mfma_f32_16x16x32_bf16 v[36:39], a[180:183], v[164:167], v[36:39]
    v_exp_f32 v69, v69
    v_mfma_f32_16x16x32_bf16 a[148:151], a[212:215], v[192:195], a[148:151]
    v_cvt_pk_bf16_f32 v206, v68, v69
    v_add_f32 v91, v91, v63
    v_mfma_f32_16x16x32_bf16 v[20:23], a[184:187], v[104:107], v[20:23]
    v_exp_f32 v70, v70
    v_mfma_f32_16x16x32_bf16 a[24:27], a[216:219], v[176:179], a[24:27]
    ds_read_b128 a[180:183], v81 offset:20992
    ds_read_b64_tr_b16 a[212:213], v84 offset:17408
    v_mfma_f32_16x16x32_bf16 v[24:27], a[184:187], v[120:123], v[24:27]
    v_exp_f32 v71, v71
    v_mfma_f32_16x16x32_bf16 a[56:59], a[216:219], v[180:183], a[56:59]
    v_cvt_pk_bf16_f32 v207, v70, v71
    v_add_f32 v95, v95, v64
    v_mfma_f32_16x16x32_bf16 v[28:31], a[184:187], v[136:139], v[28:31]
    v_exp_f32 v72, v72
    v_mfma_f32_16x16x32_bf16 a[88:91], a[216:219], v[184:187], a[88:91]
    ds_read_b64_tr_b16 a[214:215], v84 offset:21504
    s_waitcnt lgkmcnt(3)
    v_mfma_f32_16x16x32_bf16 v[32:35], a[184:187], v[152:155], v[32:35]
    v_exp_f32 v73, v73
    v_mfma_f32_16x16x32_bf16 a[120:123], a[216:219], v[188:191], a[120:123]
    v_cvt_pk_bf16_f32 v210, v72, v73
    v_add_f32 v95, v95, v65
    v_mfma_f32_16x16x32_bf16 v[36:39], a[184:187], v[168:171], v[36:39]
    v_exp_f32 v74, v74
    v_mfma_f32_16x16x32_bf16 a[152:155], a[216:219], v[192:195], a[152:155]
    ds_read_b128 a[184:187], v81 offset:21504
    ds_read_b64_tr_b16 a[216:217], v82 offset:17920
    v_mfma_f32_16x16x32_bf16 v[20:23], a[188:191], v[108:111], v[20:23]
    v_exp_f32 v75, v75
    v_mfma_f32_16x16x32_bf16 a[28:31], a[220:223], v[176:179], a[28:31]
    v_cvt_pk_bf16_f32 v211, v74, v75
    v_add_f32 v95, v95, v66
    v_mfma_f32_16x16x32_bf16 v[24:27], a[188:191], v[124:127], v[24:27]
    v_exp_f32 v76, v76
    v_mfma_f32_16x16x32_bf16 a[60:63], a[220:223], v[180:183], a[60:63]
    ds_read_b64_tr_b16 a[218:219], v82 offset:22016
    s_sub_u32 s60, s60, 1
    v_mfma_f32_16x16x32_bf16 v[28:31], a[188:191], v[140:143], v[28:31]
    v_exp_f32 v77, v77
    v_mfma_f32_16x16x32_bf16 a[92:95], a[220:223], v[184:187], a[92:95]
    v_cvt_pk_bf16_f32 v214, v76, v77
    v_add_f32 v95, v95, v67
    v_mfma_f32_16x16x32_bf16 v[32:35], a[188:191], v[156:159], v[32:35]
    v_exp_f32 v78, v78
    v_mfma_f32_16x16x32_bf16 a[124:127], a[220:223], v[188:191], a[124:127]
    buffer_load_dwordx4 v83, s[16:19], s62 offen offset:2048 nt lds
    v_mfma_f32_16x16x32_bf16 v[36:39], a[188:191], v[172:175], v[36:39]
    v_exp_f32 v79, v79
    v_mfma_f32_16x16x32_bf16 a[156:159], a[220:223], v[192:195], a[156:159]
    v_cvt_pk_bf16_f32 v215, v78, v79
    ds_read_b128 a[188:191], v81 offset:22016
    v_mfma_f32_16x16x32_bf16 a[240:243], a[244:247], v[192:195], a[240:243]
    ds_read_b64_tr_b16 a[220:221], v84 offset:17920
    ds_read_b64_tr_b16 a[222:223], v84 offset:22016
    v_mfma_f32_16x16x32_bf16 v[40:43], a[160:163], v[96:99], v[216:219]
    v_exp_f32 v0, v0
    v_mfma_f32_16x16x32_bf16 a[0:3], a[192:195], v[196:199], a[0:3]
    v_add_u32 v81, 0x8000, v81
    v_add_u32 v82, 0x8000, v82
    v_mfma_f32_16x16x32_bf16 v[44:47], a[160:163], v[112:115], v[220:223]
    v_exp_f32 v1, v1
    v_mfma_f32_16x16x32_bf16 a[32:35], a[192:195], v[200:203], a[32:35]
    v_cvt_pk_bf16_f32 v176, v0, v1
    v_add_f32 v91, v91, v0
    v_mfma_f32_16x16x32_bf16 v[48:51], a[160:163], v[128:131], v[224:227]
    v_exp_f32 v2, v2
    v_mfma_f32_16x16x32_bf16 a[64:67], a[192:195], v[204:207], a[64:67]
    v_and_b32 v81, 0x1ffff, v81
    v_and_b32 v82, 0x1ffff, v82
    v_mfma_f32_16x16x32_bf16 v[52:55], a[160:163], v[144:147], v[228:231]
    v_exp_f32 v3, v3
    v_mfma_f32_16x16x32_bf16 a[96:99], a[192:195], v[208:211], a[96:99]
    v_cvt_pk_bf16_f32 v177, v2, v3
    s_waitcnt vmcnt(8) lgkmcnt(0)
    s_barrier
    v_mfma_f32_16x16x32_bf16 v[56:59], a[160:163], v[160:163], v[232:235]
    v_exp_f32 v4, v4
    v_mfma_f32_16x16x32_bf16 a[128:131], a[192:195], v[212:215], a[128:131]
    ds_read_b128 a[160:163], v81 offset:0
    ds_read_b64_tr_b16 a[192:193], v82 offset:0
    v_mfma_f32_16x16x32_bf16 v[40:43], a[164:167], v[100:103], v[40:43]
    v_exp_f32 v5, v5
    v_mfma_f32_16x16x32_bf16 a[4:7], a[196:199], v[196:199], a[4:7]
    v_cvt_pk_bf16_f32 v180, v4, v5
    v_add_f32 v91, v91, v1
    v_mfma_f32_16x16x32_bf16 v[44:47], a[164:167], v[116:119], v[44:47]
    v_exp_f32 v6, v6
    v_mfma_f32_16x16x32_bf16 a[36:39], a[196:199], v[200:203], a[36:39]
    ds_read_b64_tr_b16 a[194:195], v82 offset:4096
    v_xor_b32 v84, 32, v82
    v_mfma_f32_16x16x32_bf16 v[48:51], a[164:167], v[132:135], v[48:51]
    v_exp_f32 v7, v7
    v_mfma_f32_16x16x32_bf16 a[68:71], a[196:199], v[204:207], a[68:71]
    v_cvt_pk_bf16_f32 v181, v6, v7
    v_add_f32 v91, v91, v2
    v_mfma_f32_16x16x32_bf16 a[232:235], a[244:247], v[204:207], a[232:235]
    s_mov_b32 m0, s70
    s_add_u32 s71, s71, 0x8000
    v_mfma_f32_16x16x32_bf16 v[52:55], a[164:167], v[148:151], v[52:55]
    v_exp_f32 v8, v8
    v_mfma_f32_16x16x32_bf16 a[100:103], a[196:199], v[208:211], a[100:103]
    buffer_load_dwordx4 v83, s[12:15], s68 offen nt lds
    s_and_b32 s71, s71, 0x1ffff
    v_mfma_f32_16x16x32_bf16 v[56:59], a[164:167], v[164:167], v[56:59]
    v_exp_f32 v9, v9
    v_mfma_f32_16x16x32_bf16 a[132:135], a[196:199], v[212:215], a[132:135]
    v_cvt_pk_bf16_f32 v184, v8, v9
    v_add_f32 v91, v91, v3
    v_mfma_f32_16x16x32_bf16 v[40:43], a[168:171], v[104:107], v[40:43]
    v_exp_f32 v10, v10
    v_mfma_f32_16x16x32_bf16 a[8:11], a[200:203], v[196:199], a[8:11]
    ds_read_b128 a[164:167], v81 offset:512
    ds_read_b64_tr_b16 a[196:197], v84 offset:0
    v_mfma_f32_16x16x32_bf16 v[44:47], a[168:171], v[120:123], v[44:47]
    v_exp_f32 v11, v11
    v_mfma_f32_16x16x32_bf16 a[40:43], a[200:203], v[200:203], a[40:43]
    v_cvt_pk_bf16_f32 v185, v10, v11
    v_add_f32 v95, v95, v4
    v_mfma_f32_16x16x32_bf16 v[48:51], a[168:171], v[136:139], v[48:51]
    v_exp_f32 v12, v12
    v_mfma_f32_16x16x32_bf16 a[72:75], a[200:203], v[204:207], a[72:75]
    ds_read_b64_tr_b16 a[198:199], v84 offset:4096
    v_mfma_f32_16x16x32_bf16 v[52:55], a[168:171], v[152:155], v[52:55]
    v_exp_f32 v13, v13
    v_mfma_f32_16x16x32_bf16 a[104:107], a[200:203], v[208:211], a[104:107]
    v_cvt_pk_bf16_f32 v188, v12, v13
    v_add_f32 v95, v95, v5
    v_mfma_f32_16x16x32_bf16 v[56:59], a[168:171], v[168:171], v[56:59]
    v_exp_f32 v14, v14
    v_mfma_f32_16x16x32_bf16 a[136:139], a[200:203], v[212:215], a[136:139]
    ds_read_b128 a[168:171], v81 offset:1024
    ds_read_b64_tr_b16 a[200:201], v82 offset:512
    v_mfma_f32_16x16x32_bf16 v[40:43], a[172:175], v[108:111], v[40:43]
    v_exp_f32 v15, v15
    v_mfma_f32_16x16x32_bf16 a[12:15], a[204:207], v[196:199], a[12:15]
    v_cvt_pk_bf16_f32 v189, v14, v15
    v_add_f32 v95, v95, v6
    v_mfma_f32_16x16x32_bf16 v[44:47], a[172:175], v[124:127], v[44:47]
    v_exp_f32 v16, v16
    v_mfma_f32_16x16x32_bf16 a[44:47], a[204:207], v[200:203], a[44:47]
    ds_read_b64_tr_b16 a[202:203], v82 offset:4608
    s_waitcnt lgkmcnt(3)
    v_mfma_f32_16x16x32_bf16 v[48:51], a[172:175], v[140:143], v[48:51]
    v_exp_f32 v17, v17
    v_mfma_f32_16x16x32_bf16 a[76:79], a[204:207], v[204:207], a[76:79]
    v_cvt_pk_bf16_f32 v192, v16, v17
    v_add_f32 v95, v95, v7
    v_mfma_f32_16x16x32_bf16 v[52:55], a[172:175], v[156:159], v[52:55]
    v_exp_f32 v18, v18
    v_mfma_f32_16x16x32_bf16 a[108:111], a[204:207], v[208:211], a[108:111]
    buffer_load_dwordx4 v83, s[12:15], s68 offen offset:2048 nt lds
    v_mfma_f32_16x16x32_bf16 v[56:59], a[172:175], v[172:175], v[56:59]
    v_exp_f32 v19, v19
    v_mfma_f32_16x16x32_bf16 a[140:143], a[204:207], v[212:215], a[140:143]
    v_cvt_pk_bf16_f32 v193, v18, v19
    v_mfma_f32_16x16x32_bf16 v[60:63], a[176:179], v[96:99], v[216:219]
    v_exp_f32 v20, v20
    v_mfma_f32_16x16x32_bf16 a[16:19], a[208:211], v[196:199], a[16:19]
    ds_read_b128 a[172:175], v81 offset:1536
    ds_read_b64_tr_b16 a[204:205], v84 offset:512
    v_mfma_f32_16x16x32_bf16 v[64:67], a[176:179], v[112:115], v[220:223]
    v_exp_f32 v21, v21
    v_mfma_f32_16x16x32_bf16 a[48:51], a[208:211], v[200:203], a[48:51]
    v_cvt_pk_bf16_f32 v178, v20, v21
    v_mfma_f32_16x16x32_bf16 v[68:71], a[176:179], v[128:131], v[224:227]
    v_exp_f32 v22, v22
    v_mfma_f32_16x16x32_bf16 a[80:83], a[208:211], v[204:207], a[80:83]
    ds_read_b64_tr_b16 a[206:207], v84 offset:4608
    s_mov_b32 m0, s71
    v_mfma_f32_16x16x32_bf16 v[72:75], a[176:179], v[144:147], v[228:231]
    v_exp_f32 v23, v23
    v_mfma_f32_16x16x32_bf16 a[112:115], a[208:211], v[208:211], a[112:115]
    v_cvt_pk_bf16_f32 v179, v22, v23
    v_add_f32 v91, v91, v20
    v_mfma_f32_16x16x32_bf16 a[236:239], a[244:247], v[208:211], a[236:239]
    v_mfma_f32_16x16x32_bf16 v[76:79], a[176:179], v[160:163], v[232:235]
    v_exp_f32 v24, v24
    v_mfma_f32_16x16x32_bf16 a[144:147], a[208:211], v[212:215], a[144:147]
    ds_read_b128 a[176:179], v81 offset:4096
    ds_read_b64_tr_b16 a[208:209], v82 offset:1024
    v_mfma_f32_16x16x32_bf16 v[60:63], a[180:183], v[100:103], v[60:63]
    v_exp_f32 v25, v25
    v_mfma_f32_16x16x32_bf16 a[20:23], a[212:215], v[196:199], a[20:23]
    v_cvt_pk_bf16_f32 v182, v24, v25
    v_add_f32 v91, v91, v21
    v_mfma_f32_16x16x32_bf16 v[64:67], a[180:183], v[116:119], v[64:67]
    v_exp_f32 v26, v26
    v_mfma_f32_16x16x32_bf16 a[52:55], a[212:215], v[200:203], a[52:55]
    ds_read_b64_tr_b16 a[210:211], v82 offset:5120
    v_mfma_f32_16x16x32_bf16 v[68:71], a[180:183], v[132:135], v[68:71]
    v_exp_f32 v27, v27
    v_mfma_f32_16x16x32_bf16 a[84:87], a[212:215], v[204:207], a[84:87]
    v_cvt_pk_bf16_f32 v183, v26, v27
    v_add_f32 v91, v91, v22
    v_mfma_f32_16x16x32_bf16 v[72:75], a[180:183], v[148:151], v[72:75]
    v_exp_f32 v28, v28
    v_mfma_f32_16x16x32_bf16 a[116:119], a[212:215], v[208:211], a[116:119]
    buffer_load_dwordx4 v83, s[16:19], s69 offen nt lds
    v_mfma_f32_16x16x32_bf16 v[76:79], a[180:183], v[164:167], v[76:79]
    v_exp_f32 v29, v29
    v_mfma_f32_16x16x32_bf16 a[148:151], a[212:215], v[212:215], a[148:151]
    v_cvt_pk_bf16_f32 v186, v28, v29
    v_add_f32 v91, v91, v23
    v_mfma_f32_16x16x32_bf16 v[60:63], a[184:187], v[104:107], v[60:63]
    v_exp_f32 v30, v30
    v_mfma_f32_16x16x32_bf16 a[24:27], a[216:219], v[196:199], a[24:27]
    ds_read_b128 a[180:183], v81 offset:4608
    ds_read_b64_tr_b16 a[212:213], v84 offset:1024
    v_mfma_f32_16x16x32_bf16 v[64:67], a[184:187], v[120:123], v[64:67]
    v_exp_f32 v31, v31
    v_mfma_f32_16x16x32_bf16 a[56:59], a[216:219], v[200:203], a[56:59]
    v_cvt_pk_bf16_f32 v187, v30, v31
    v_add_f32 v95, v95, v24
    v_mfma_f32_16x16x32_bf16 v[68:71], a[184:187], v[136:139], v[68:71]
    v_exp_f32 v32, v32
    v_mfma_f32_16x16x32_bf16 a[88:91], a[216:219], v[204:207], a[88:91]
    ds_read_b64_tr_b16 a[214:215], v84 offset:5120
    s_waitcnt lgkmcnt(3)
    v_mfma_f32_16x16x32_bf16 v[72:75], a[184:187], v[152:155], v[72:75]
    v_exp_f32 v33, v33
    v_mfma_f32_16x16x32_bf16 a[120:123], a[216:219], v[208:211], a[120:123]
    v_cvt_pk_bf16_f32 v190, v32, v33
    v_add_f32 v95, v95, v25
    v_mfma_f32_16x16x32_bf16 v[76:79], a[184:187], v[168:171], v[76:79]
    v_exp_f32 v34, v34
    v_mfma_f32_16x16x32_bf16 a[152:155], a[216:219], v[212:215], a[152:155]
    ds_read_b128 a[184:187], v81 offset:5120
    ds_read_b64_tr_b16 a[216:217], v82 offset:1536
    v_mfma_f32_16x16x32_bf16 v[60:63], a[188:191], v[108:111], v[60:63]
    v_exp_f32 v35, v35
    v_mfma_f32_16x16x32_bf16 a[28:31], a[220:223], v[196:199], a[28:31]
    v_cvt_pk_bf16_f32 v191, v34, v35
    v_add_f32 v95, v95, v26
    v_mfma_f32_16x16x32_bf16 v[64:67], a[188:191], v[124:127], v[64:67]
    v_exp_f32 v36, v36
    v_mfma_f32_16x16x32_bf16 a[60:63], a[220:223], v[200:203], a[60:63]
    ds_read_b64_tr_b16 a[218:219], v82 offset:5632
    v_mfma_f32_16x16x32_bf16 v[68:71], a[188:191], v[140:143], v[68:71]
    v_exp_f32 v37, v37
    v_mfma_f32_16x16x32_bf16 a[92:95], a[220:223], v[204:207], a[92:95]
    v_cvt_pk_bf16_f32 v194, v36, v37
    v_add_f32 v95, v95, v27
    v_mfma_f32_16x16x32_bf16 v[72:75], a[188:191], v[156:159], v[72:75]
    v_exp_f32 v38, v38
    v_mfma_f32_16x16x32_bf16 a[124:127], a[220:223], v[208:211], a[124:127]
    buffer_load_dwordx4 v83, s[16:19], s69 offen offset:2048 nt lds
    v_mfma_f32_16x16x32_bf16 v[76:79], a[188:191], v[172:175], v[76:79]
    v_exp_f32 v39, v39
    v_mfma_f32_16x16x32_bf16 a[156:159], a[220:223], v[212:215], a[156:159]
    v_cvt_pk_bf16_f32 v195, v38, v39
    ds_read_b128 a[188:191], v81 offset:5632
    v_mfma_f32_16x16x32_bf16 a[240:243], a[244:247], v[212:215], a[240:243]
    ds_read_b64_tr_b16 a[220:221], v84 offset:1536
    ds_read_b64_tr_b16 a[222:223], v84 offset:5632
    s_cmp_lg_u32 s60, 0
    s_cbranch_scc1 L_loop
L_p31:
    v_exp_f32 v40, v40
    v_mfma_f32_16x16x32_bf16 a[0:3], a[192:195], v[176:179], a[0:3]
    v_exp_f32 v41, v41
    v_mfma_f32_16x16x32_bf16 a[32:35], a[192:195], v[180:183], a[32:35]
    v_exp_f32 v42, v42
    v_cvt_pk_bf16_f32 v196, v40, v41
    v_add_f32 v91, v91, v40
    v_mfma_f32_16x16x32_bf16 a[64:67], a[192:195], v[184:187], a[64:67]
    v_exp_f32 v43, v43
    s_waitcnt lgkmcnt(3)
    v_mfma_f32_16x16x32_bf16 a[96:99], a[192:195], v[188:191], a[96:99]
    v_exp_f32 v44, v44
    v_cvt_pk_bf16_f32 v197, v42, v43
    v_mfma_f32_16x16x32_bf16 a[128:131], a[192:195], v[192:195], a[128:131]
    v_exp_f32 v45, v45
    ds_read_b64_tr_b16 a[192:193], v82 offset:16384
    v_mfma_f32_16x16x32_bf16 a[4:7], a[196:199], v[176:179], a[4:7]
    v_exp_f32 v46, v46
    v_cvt_pk_bf16_f32 v200, v44, v45
    v_add_f32 v91, v91, v41
    v_mfma_f32_16x16x32_bf16 a[36:39], a[196:199], v[180:183], a[36:39]
    v_exp_f32 v47, v47
    ds_read_b64_tr_b16 a[194:195], v82 offset:20480
    v_mfma_f32_16x16x32_bf16 a[68:71], a[196:199], v[184:187], a[68:71]
    v_exp_f32 v48, v48
    v_cvt_pk_bf16_f32 v201, v46, v47
    v_add_f32 v91, v91, v42
    v_mfma_f32_16x16x32_bf16 a[232:235], a[244:247], v[184:187], a[232:235]
    s_add_u32 m0, s70, 16384
    s_add_u32 s61, s68, 8192
    v_mfma_f32_16x16x32_bf16 a[100:103], a[196:199], v[188:191], a[100:103]
    v_exp_f32 v49, v49
    v_mfma_f32_16x16x32_bf16 a[132:135], a[196:199], v[192:195], a[132:135]
    v_exp_f32 v50, v50
    v_cvt_pk_bf16_f32 v204, v48, v49
    v_add_f32 v91, v91, v43
    v_mfma_f32_16x16x32_bf16 a[8:11], a[200:203], v[176:179], a[8:11]
    v_exp_f32 v51, v51
    ds_read_b64_tr_b16 a[196:197], v84 offset:16384
    v_mfma_f32_16x16x32_bf16 a[40:43], a[200:203], v[180:183], a[40:43]
    v_exp_f32 v52, v52
    v_cvt_pk_bf16_f32 v205, v50, v51
    v_add_f32 v95, v95, v44
    v_mfma_f32_16x16x32_bf16 a[72:75], a[200:203], v[184:187], a[72:75]
    v_exp_f32 v53, v53
    ds_read_b64_tr_b16 a[198:199], v84 offset:20480
    s_add_u32 s70, s70, 0x8000
    v_mfma_f32_16x16x32_bf16 a[104:107], a[200:203], v[188:191], a[104:107]
    v_exp_f32 v54, v54
    v_cvt_pk_bf16_f32 v208, v52, v53
    v_add_f32 v95, v95, v45
    v_mfma_f32_16x16x32_bf16 a[136:139], a[200:203], v[192:195], a[136:139]
    v_exp_f32 v55, v55
    ds_read_b64_tr_b16 a[200:201], v82 offset:16896
    v_mfma_f32_16x16x32_bf16 a[12:15], a[204:207], v[176:179], a[12:15]
    v_exp_f32 v56, v56
    v_cvt_pk_bf16_f32 v209, v54, v55
    v_add_f32 v95, v95, v46
    v_mfma_f32_16x16x32_bf16 a[44:47], a[204:207], v[180:183], a[44:47]
    v_exp_f32 v57, v57
    ds_read_b64_tr_b16 a[202:203], v82 offset:20992
    s_waitcnt lgkmcnt(3)
    v_mfma_f32_16x16x32_bf16 a[76:79], a[204:207], v[184:187], a[76:79]
    v_exp_f32 v58, v58
    v_cvt_pk_bf16_f32 v212, v56, v57
    v_add_f32 v95, v95, v47
    v_mfma_f32_16x16x32_bf16 a[108:111], a[204:207], v[188:191], a[108:111]
    v_exp_f32 v59, v59
    s_and_b32 s70, s70, 0x1ffff
    v_mfma_f32_16x16x32_bf16 a[140:143], a[204:207], v[192:195], a[140:143]
    v_exp_f32 v60, v60
    v_cvt_pk_bf16_f32 v213, v58, v59
    v_mfma_f32_16x16x32_bf16 a[16:19], a[208:211], v[176:179], a[16:19]
    v_exp_f32 v61, v61
    ds_read_b64_tr_b16 a[204:205], v84 offset:16896
    v_mfma_f32_16x16x32_bf16 a[48:51], a[208:211], v[180:183], a[48:51]
    v_exp_f32 v62, v62
    v_cvt_pk_bf16_f32 v198, v60, v61
    v_mfma_f32_16x16x32_bf16 a[80:83], a[208:211], v[184:187], a[80:83]
    v_exp_f32 v63, v63
    ds_read_b64_tr_b16 a[206:207], v84 offset:20992
    s_add_u32 m0, s71, 16384
    v_mfma_f32_16x16x32_bf16 a[112:115], a[208:211], v[188:191], a[112:115]
    v_exp_f32 v64, v64
    v_cvt_pk_bf16_f32 v199, v62, v63
    v_add_f32 v91, v91, v60
    v_mfma_f32_16x16x32_bf16 a[236:239], a[244:247], v[188:191], a[236:239]
    s_add_u32 s62, s69, 8192
    v_mfma_f32_16x16x32_bf16 a[144:147], a[208:211], v[192:195], a[144:147]
    v_exp_f32 v65, v65
    ds_read_b64_tr_b16 a[208:209], v82 offset:17408
    v_mfma_f32_16x16x32_bf16 a[20:23], a[212:215], v[176:179], a[20:23]
    v_exp_f32 v66, v66
    v_cvt_pk_bf16_f32 v202, v64, v65
    v_add_f32 v91, v91, v61
    v_mfma_f32_16x16x32_bf16 a[52:55], a[212:215], v[180:183], a[52:55]
    v_exp_f32 v67, v67
    ds_read_b64_tr_b16 a[210:211], v82 offset:21504
    s_add_u32 s68, s68, 16384
    v_mfma_f32_16x16x32_bf16 a[84:87], a[212:215], v[184:187], a[84:87]
    v_exp_f32 v68, v68
    v_cvt_pk_bf16_f32 v203, v66, v67
    v_add_f32 v91, v91, v62
    v_mfma_f32_16x16x32_bf16 a[116:119], a[212:215], v[188:191], a[116:119]
    v_exp_f32 v69, v69
    s_add_u32 s69, s69, 16384
    v_mfma_f32_16x16x32_bf16 a[148:151], a[212:215], v[192:195], a[148:151]
    v_exp_f32 v70, v70
    v_cvt_pk_bf16_f32 v206, v68, v69
    v_add_f32 v91, v91, v63
    v_mfma_f32_16x16x32_bf16 a[24:27], a[216:219], v[176:179], a[24:27]
    v_exp_f32 v71, v71
    ds_read_b64_tr_b16 a[212:213], v84 offset:17408
    v_mfma_f32_16x16x32_bf16 a[56:59], a[216:219], v[180:183], a[56:59]
    v_exp_f32 v72, v72
    v_cvt_pk_bf16_f32 v207, v70, v71
    v_add_f32 v95, v95, v64
    v_mfma_f32_16x16x32_bf16 a[88:91], a[216:219], v[184:187], a[88:91]
    v_exp_f32 v73, v73
    ds_read_b64_tr_b16 a[214:215], v84 offset:21504
    s_waitcnt lgkmcnt(3)
    v_mfma_f32_16x16x32_bf16 a[120:123], a[216:219], v[188:191], a[120:123]
    v_exp_f32 v74, v74
    v_cvt_pk_bf16_f32 v210, v72, v73
    v_add_f32 v95, v95, v65
    v_mfma_f32_16x16x32_bf16 a[152:155], a[216:219], v[192:195], a[152:155]
    v_exp_f32 v75, v75
    ds_read_b64_tr_b16 a[216:217], v82 offset:17920
    v_mfma_f32_16x16x32_bf16 a[28:31], a[220:223], v[176:179], a[28:31]
    v_exp_f32 v76, v76
    v_cvt_pk_bf16_f32 v211, v74, v75
    v_add_f32 v95, v95, v66
    v_mfma_f32_16x16x32_bf16 a[60:63], a[220:223], v[180:183], a[60:63]
    v_exp_f32 v77, v77
    ds_read_b64_tr_b16 a[218:219], v82 offset:22016
    s_sub_u32 s60, s60, 1
    v_mfma_f32_16x16x32_bf16 a[92:95], a[220:223], v[184:187], a[92:95]
    v_exp_f32 v78, v78
    v_cvt_pk_bf16_f32 v214, v76, v77
    v_add_f32 v95, v95, v67
    v_mfma_f32_16x16x32_bf16 a[124:127], a[220:223], v[188:191], a[124:127]
    v_exp_f32 v79, v79
    v_mfma_f32_16x16x32_bf16 a[156:159], a[220:223], v[192:195], a[156:159]
    s_nop 0
    v_cvt_pk_bf16_f32 v215, v78, v79
    v_mfma_f32_16x16x32_bf16 a[240:243], a[244:247], v[192:195], a[240:243]
    ds_read_b64_tr_b16 a[220:221], v84 offset:17920
    ds_read_b64_tr_b16 a[222:223], v84 offset:22016
    s_waitcnt vmcnt(0) lgkmcnt(0)
    s_barrier
    v_lshrrev_b32 v32, 2, v80
    v_and_b32 v32, 7, v32
    v_lshrrev_b32 v33, 5, v80
    v_and_b32 v34, 3, v80
    v_lshlrev_b32 v33, 6, v33
    v_lshl_add_u32 v33, v34, 4, v33
    s_movk_i32 s61, 1152
    v_mad_u32_u24 v85, v32, s61, v33
    s_mul_i32 s64, s28, 73728
    s_lshl_b32 s65, s28, 13
    v_mfma_f32_16x16x32_bf16 a[232:235], a[244:247], v[204:207], a[232:235]
    s_add_u32 m0, s65, 0
    s_mov_b32 s61, s64
    v_mfma_f32_16x16x32_bf16 a[236:239], a[244:247], v[208:211], a[236:239]
    buffer_load_dwordx4 v85, s[24:27], s61 offen lds
    s_add_u32 m0, s65, 1024
    v_mfma_f32_16x16x32_bf16 a[240:243], a[244:247], v[212:215], a[240:243]
    s_add_u32 s61, s64, 9216
    buffer_load_dwordx4 v85, s[24:27], s61 offen lds
    v_mfma_f32_16x16x32_bf16 a[0:3], a[192:195], v[196:199], a[0:3]
    s_add_u32 m0, s65, 2048
    s_add_u32 s61, s64, 18432
    v_mfma_f32_16x16x32_bf16 a[32:35], a[192:195], v[200:203], a[32:35]
    buffer_load_dwordx4 v85, s[24:27], s61 offen lds
    s_add_u32 m0, s65, 3072
    v_mfma_f32_16x16x32_bf16 a[64:67], a[192:195], v[204:207], a[64:67]
    s_add_u32 s61, s64, 27648
    buffer_load_dwordx4 v85, s[24:27], s61 offen lds
    v_mfma_f32_16x16x32_bf16 a[96:99], a[192:195], v[208:211], a[96:99]
    s_add_u32 m0, s65, 4096
    s_add_u32 s61, s64, 36864
    v_mfma_f32_16x16x32_bf16 a[128:131], a[192:195], v[212:215], a[128:131]
    buffer_load_dwordx4 v85, s[24:27], s61 offen lds
    s_add_u32 m0, s65, 5120
    v_mfma_f32_16x16x32_bf16 a[4:7], a[196:199], v[196:199], a[4:7]
    s_add_u32 s61, s64, 46080
    buffer_load_dwordx4 v85, s[24:27], s61 offen lds
    v_mfma_f32_16x16x32_bf16 a[36:39], a[196:199], v[200:203], a[36:39]
    s_add_u32 m0, s65, 6144
    s_add_u32 s61, s64, 55296
    v_mfma_f32_16x16x32_bf16 a[68:71], a[196:199], v[204:207], a[68:71]
    buffer_load_dwordx4 v85, s[24:27], s61 offen lds
    s_add_u32 m0, s65, 7168
    v_mfma_f32_16x16x32_bf16 a[100:103], a[196:199], v[208:211], a[100:103]
    s_add_u32 s61, s64, 64512
    buffer_load_dwordx4 v85, s[24:27], s61 offen lds
    v_mfma_f32_16x16x32_bf16 a[132:135], a[196:199], v[212:215], a[132:135]
    s_add_u32 s64, s64, 128
    s_add_u32 m0, s65, 32768
    v_mfma_f32_16x16x32_bf16 a[8:11], a[200:203], v[196:199], a[8:11]
    s_mov_b32 s61, s64
    buffer_load_dwordx4 v85, s[24:27], s61 offen lds
    v_mfma_f32_16x16x32_bf16 a[40:43], a[200:203], v[200:203], a[40:43]
    s_add_u32 m0, s65, 33792
    s_add_u32 s61, s64, 9216
    v_mfma_f32_16x16x32_bf16 a[72:75], a[200:203], v[204:207], a[72:75]
    buffer_load_dwordx4 v85, s[24:27], s61 offen lds
    s_add_u32 m0, s65, 34816
    v_mfma_f32_16x16x32_bf16 a[104:107], a[200:203], v[208:211], a[104:107]
    s_add_u32 s61, s64, 18432
    buffer_load_dwordx4 v85, s[24:27], s61 offen lds
    v_mfma_f32_16x16x32_bf16 a[136:139], a[200:203], v[212:215], a[136:139]
    s_add_u32 m0, s65, 35840
    s_add_u32 s61, s64, 27648
    v_mfma_f32_16x16x32_bf16 a[12:15], a[204:207], v[196:199], a[12:15]
    buffer_load_dwordx4 v85, s[24:27], s61 offen lds
    s_add_u32 m0, s65, 36864
    v_mfma_f32_16x16x32_bf16 a[44:47], a[204:207], v[200:203], a[44:47]
    s_add_u32 s61, s64, 36864
    buffer_load_dwordx4 v85, s[24:27], s61 offen lds
    v_mfma_f32_16x16x32_bf16 a[76:79], a[204:207], v[204:207], a[76:79]
    s_add_u32 m0, s65, 37888
    s_add_u32 s61, s64, 46080
    v_mfma_f32_16x16x32_bf16 a[108:111], a[204:207], v[208:211], a[108:111]
    buffer_load_dwordx4 v85, s[24:27], s61 offen lds
    s_add_u32 m0, s65, 38912
    v_mfma_f32_16x16x32_bf16 a[140:143], a[204:207], v[212:215], a[140:143]
    s_add_u32 s61, s64, 55296
    buffer_load_dwordx4 v85, s[24:27], s61 offen lds
    v_mfma_f32_16x16x32_bf16 a[16:19], a[208:211], v[196:199], a[16:19]
    s_add_u32 m0, s65, 39936
    s_add_u32 s61, s64, 64512
    v_mfma_f32_16x16x32_bf16 a[48:51], a[208:211], v[200:203], a[48:51]
    buffer_load_dwordx4 v85, s[24:27], s61 offen lds
    s_add_u32 s64, s64, 128
    v_mfma_f32_16x16x32_bf16 a[80:83], a[208:211], v[204:207], a[80:83]
    v_mfma_f32_16x16x32_bf16 a[112:115], a[208:211], v[208:211], a[112:115]
    v_mfma_f32_16x16x32_bf16 a[144:147], a[208:211], v[212:215], a[144:147]
    v_mfma_f32_16x16x32_bf16 a[20:23], a[212:215], v[196:199], a[20:23]
    v_mfma_f32_16x16x32_bf16 a[52:55], a[212:215], v[200:203], a[52:55]
    v_mfma_f32_16x16x32_bf16 a[84:87], a[212:215], v[204:207], a[84:87]
    v_mfma_f32_16x16x32_bf16 a[116:119], a[212:215], v[208:211], a[116:119]
    v_mfma_f32_16x16x32_bf16 a[148:151], a[212:215], v[212:215], a[148:151]
    v_mfma_f32_16x16x32_bf16 a[24:27], a[216:219], v[196:199], a[24:27]
    v_mfma_f32_16x16x32_bf16 a[56:59], a[216:219], v[200:203], a[56:59]
    v_mfma_f32_16x16x32_bf16 a[88:91], a[216:219], v[204:207], a[88:91]
    v_mfma_f32_16x16x32_bf16 a[120:123], a[216:219], v[208:211], a[120:123]
    v_mfma_f32_16x16x32_bf16 a[152:155], a[216:219], v[212:215], a[152:155]
    v_mfma_f32_16x16x32_bf16 a[28:31], a[220:223], v[196:199], a[28:31]
    v_mfma_f32_16x16x32_bf16 a[60:63], a[220:223], v[200:203], a[60:63]
    v_mfma_f32_16x16x32_bf16 a[92:95], a[220:223], v[204:207], a[92:95]
    v_mfma_f32_16x16x32_bf16 a[124:127], a[220:223], v[208:211], a[124:127]
    v_mfma_f32_16x16x32_bf16 a[156:159], a[220:223], v[212:215], a[156:159]
    v_accvgpr_read_b32 v76, a232
    v_accvgpr_read_b32 v77, a236
    v_accvgpr_read_b32 v78, a240
    v_mov_b32 v74, v91
    v_mov_b32 v75, v95
    v_mov_b32 v89, v74
    v_mov_b32 v90, v75
    s_nop 1
    v_permlane32_swap_b32 v74, v89
    v_permlane32_swap_b32 v75, v90
    s_nop 1
    v_add_f32 v74, v74, v89
    v_add_f32 v75, v75, v90
    v_mov_b32 v89, v74
    v_mov_b32 v90, v75
    s_nop 1
    v_permlane16_swap_b32 v74, v89
    v_permlane16_swap_b32 v75, v90
    s_nop 1
    v_add_f32 v74, v74, v89
    v_add_f32 v75, v75, v90
    s_mov_b32 s61, 0x4b800000
    v_add_f32 v89, v74, v75
    v_add_f32 v90, v76, v77
    v_add_f32 v89, v89, v90
    v_add_f32 v89, v89, v78
    v_cmp_ngt_f32 vcc, s61, v89
    v_rcp_f32 v64, v74
    v_rcp_f32 v66, v75
    v_rcp_f32 v68, v76
    v_rcp_f32 v70, v77
    v_rcp_f32 v72, v78
    s_cmp_lg_u64 vcc, 0
    s_cselect_b32 s75, 1, 0
    v_mov_b32 v89, s75
    s_lshl_b32 s61, s28, 2
    s_add_u32 s61, s61, 163776
    v_mov_b32 v90, s61
    s_mul_i32 s61, s28, 20480
    s_add_u32 s61, s61, 65536
    ds_write_b32 v90, v89
    v_lshlrev_b32 v88, 4, v80
    v_add_u32 v86, s61, v88
    s_xor_b32 s62, s28, 2
    s_mul_i32 s62, s62, 20480
    s_add_u32 s62, s62, 65536
    v_add_u32 v87, s62, v88
    v_lshrrev_b32 v32, 5, v80
    v_lshrrev_b32 v33, 2, v80
    v_and_b32 v33, 7, v33
    v_and_b32 v34, 3, v80
    v_lshlrev_b32 v32, 10, v32
    v_lshl_add_u32 v32, v33, 6, v32
    v_lshl_add_u32 v32, v34, 4, v32
    s_lshr_b32 s61, s28, 1
    s_lshl_b32 s62, s61, 9
    s_lshl_b32 s63, s61, 14
    s_add_u32 s76, s62, s63
    v_add_u32 v84, s76, v32
    s_xor_b32 s63, s63, 16384
    s_add_u32 s76, s62, s63
    v_add_u32 v94, s76, v32
    s_lshl_b32 s62, s29, 3
    s_add_u32 s62, s62, s30
    s_lshl_b32 s62, s62, 4
    s_add_u32 s62, s62, s31
    s_mul_i32 s74, s62, 184320
    s_mul_i32 s61, s61, 10240
    s_add_u32 s74, s74, s61
    s_and_b32 s61, s28, 1
    s_mul_i32 s61, s61, 5120
    s_add_u32 s77, s74, s61
    s_mov_b32 s74, 0x70000000
    s_mov_b32 s59, 2
    v_accvgpr_read_b32 v0, a0
    v_accvgpr_read_b32 v1, a1
    v_accvgpr_read_b32 v2, a2
    v_accvgpr_read_b32 v3, a3
    v_accvgpr_read_b32 v4, a4
    v_accvgpr_read_b32 v5, a5
    v_accvgpr_read_b32 v6, a6
    v_accvgpr_read_b32 v7, a7
    v_pk_mul_f32 v[0:1], v[0:1], v[64:65] op_sel_hi:[1,0]
    v_pk_mul_f32 v[2:3], v[2:3], v[64:65] op_sel_hi:[1,0]
    v_pk_mul_f32 v[4:5], v[4:5], v[64:65] op_sel_hi:[1,0]
    v_pk_mul_f32 v[6:7], v[6:7], v[64:65] op_sel_hi:[1,0]
    v_cvt_pk_bf16_f32 v176, v0, v1
    v_cvt_pk_bf16_f32 v177, v2, v3
    v_cvt_pk_bf16_f32 v178, v4, v5
    v_cvt_pk_bf16_f32 v179, v6, v7
    ds_write_b128 v86, v[176:179] offset:0
    v_accvgpr_read_b32 v8, a8
    v_accvgpr_read_b32 v9, a9
    v_accvgpr_read_b32 v10, a10
    v_accvgpr_read_b32 v11, a11
    v_accvgpr_read_b32 v12, a12
    v_accvgpr_read_b32 v13, a13
    v_accvgpr_read_b32 v14, a14
    v_accvgpr_read_b32 v15, a15
    v_pk_mul_f32 v[8:9], v[8:9], v[64:65] op_sel_hi:[1,0]
    v_pk_mul_f32 v[10:11], v[10:11], v[64:65] op_sel_hi:[1,0]
    v_pk_mul_f32 v[12:13], v[12:13], v[64:65] op_sel_hi:[1,0]
    v_pk_mul_f32 v[14:15], v[14:15], v[64:65] op_sel_hi:[1,0]
    v_cvt_pk_bf16_f32 v180, v8, v9
    v_cvt_pk_bf16_f32 v181, v10, v11
    v_cvt_pk_bf16_f32 v182, v12, v13
    v_cvt_pk_bf16_f32 v183, v14, v15
    ds_write_b128 v86, v[180:183] offset:1024
    v_accvgpr_read_b32 v16, a16
    v_accvgpr_read_b32 v17, a17
    v_accvgpr_read_b32 v18, a18
    v_accvgpr_read_b32 v19, a19
    v_accvgpr_read_b32 v20, a20
    v_accvgpr_read_b32 v21, a21
    v_accvgpr_read_b32 v22, a22
    v_accvgpr_read_b32 v23, a23
    v_pk_mul_f32 v[16:17], v[16:17], v[64:65] op_sel_hi:[1,0]
    v_pk_mul_f32 v[18:19], v[18:19], v[64:65] op_sel_hi:[1,0]
    v_pk_mul_f32 v[20:21], v[20:21], v[64:65] op_sel_hi:[1,0]
    v_pk_mul_f32 v[22:23], v[22:23], v[64:65] op_sel_hi:[1,0]
    v_cvt_pk_bf16_f32 v184, v16, v17
    v_cvt_pk_bf16_f32 v185, v18, v19
    v_cvt_pk_bf16_f32 v186, v20, v21
    v_cvt_pk_bf16_f32 v187, v22, v23
    ds_write_b128 v86, v[184:187] offset:2048
    v_accvgpr_read_b32 v24, a24
    v_accvgpr_read_b32 v25, a25
    v_accvgpr_read_b32 v26, a26
    v_accvgpr_read_b32 v27, a27
    v_accvgpr_read_b32 v28, a28
    v_accvgpr_read_b32 v29, a29
    v_accvgpr_read_b32 v30, a30
    v_accvgpr_read_b32 v31, a31
    v_pk_mul_f32 v[24:25], v[24:25], v[64:65] op_sel_hi:[1,0]
    v_pk_mul_f32 v[26:27], v[26:27], v[64:65] op_sel_hi:[1,0]
    v_pk_mul_f32 v[28:29], v[28:29], v[64:65] op_sel_hi:[1,0]
    v_pk_mul_f32 v[30:31], v[30:31], v[64:65] op_sel_hi:[1,0]
    v_cvt_pk_bf16_f32 v188, v24, v25
    v_cvt_pk_bf16_f32 v189, v26, v27
    v_cvt_pk_bf16_f32 v190, v28, v29
    v_cvt_pk_bf16_f32 v191, v30, v31
    ds_write_b128 v86, v[188:191] offset:3072
    v_accvgpr_read_b32 v0, a32
    v_accvgpr_read_b32 v1, a33
    v_accvgpr_read_b32 v2, a34
    v_accvgpr_read_b32 v3, a35
    v_accvgpr_read_b32 v4, a36
    v_accvgpr_read_b32 v5, a37
    v_accvgpr_read_b32 v6, a38
    v_accvgpr_read_b32 v7, a39
    v_pk_mul_f32 v[0:1], v[0:1], v[66:67] op_sel_hi:[1,0]
    v_pk_mul_f32 v[2:3], v[2:3], v[66:67] op_sel_hi:[1,0]
    v_pk_mul_f32 v[4:5], v[4:5], v[66:67] op_sel_hi:[1,0]
    v_pk_mul_f32 v[6:7], v[6:7], v[66:67] op_sel_hi:[1,0]
    v_cvt_pk_bf16_f32 v192, v0, v1
    v_cvt_pk_bf16_f32 v193, v2, v3
    v_cvt_pk_bf16_f32 v194, v4, v5
    v_cvt_pk_bf16_f32 v195, v6, v7
    ds_write_b128 v86, v[192:195] offset:4096
    v_accvgpr_read_b32 v8, a40
    v_accvgpr_read_b32 v9, a41
    v_accvgpr_read_b32 v10, a42
    v_accvgpr_read_b32 v11, a43
    v_accvgpr_read_b32 v12, a44
    v_accvgpr_read_b32 v13, a45
    v_accvgpr_read_b32 v14, a46
    v_accvgpr_read_b32 v15, a47
    v_pk_mul_f32 v[8:9], v[8:9], v[66:67] op_sel_hi:[1,0]
    v_pk_mul_f32 v[10:11], v[10:11], v[66:67] op_sel_hi:[1,0]
    v_pk_mul_f32 v[12:13], v[12:13], v[66:67] op_sel_hi:[1,0]
    v_pk_mul_f32 v[14:15], v[14:15], v[66:67] op_sel_hi:[1,0]
    v_cvt_pk_bf16_f32 v196, v8, v9
    v_cvt_pk_bf16_f32 v197, v10, v11
    v_cvt_pk_bf16_f32 v198, v12, v13
    v_cvt_pk_bf16_f32 v199, v14, v15
    ds_write_b128 v86, v[196:199] offset:5120
    v_accvgpr_read_b32 v16, a48
    v_accvgpr_read_b32 v17, a49
    v_accvgpr_read_b32 v18, a50
    v_accvgpr_read_b32 v19, a51
    v_accvgpr_read_b32 v20, a52
    v_accvgpr_read_b32 v21, a53
    v_accvgpr_read_b32 v22, a54
    v_accvgpr_read_b32 v23, a55
    v_pk_mul_f32 v[16:17], v[16:17], v[66:67] op_sel_hi:[1,0]
    v_pk_mul_f32 v[18:19], v[18:19], v[66:67] op_sel_hi:[1,0]
    v_pk_mul_f32 v[20:21], v[20:21], v[66:67] op_sel_hi:[1,0]
    v_pk_mul_f32 v[22:23], v[22:23], v[66:67] op_sel_hi:[1,0]
    v_cvt_pk_bf16_f32 v200, v16, v17
    v_cvt_pk_bf16_f32 v201, v18, v19
    v_cvt_pk_bf16_f32 v202, v20, v21
    v_cvt_pk_bf16_f32 v203, v22, v23
    ds_write_b128 v86, v[200:203] offset:6144
    v_accvgpr_read_b32 v24, a56
    v_accvgpr_read_b32 v25, a57
    v_accvgpr_read_b32 v26, a58
    v_accvgpr_read_b32 v27, a59
    v_accvgpr_read_b32 v28, a60
    v_accvgpr_read_b32 v29, a61
    v_accvgpr_read_b32 v30, a62
    v_accvgpr_read_b32 v31, a63
    v_pk_mul_f32 v[24:25], v[24:25], v[66:67] op_sel_hi:[1,0]
    v_pk_mul_f32 v[26:27], v[26:27], v[66:67] op_sel_hi:[1,0]
    v_pk_mul_f32 v[28:29], v[28:29], v[66:67] op_sel_hi:[1,0]
    v_pk_mul_f32 v[30:31], v[30:31], v[66:67] op_sel_hi:[1,0]
    v_cvt_pk_bf16_f32 v204, v24, v25
    v_cvt_pk_bf16_f32 v205, v26, v27
    v_cvt_pk_bf16_f32 v206, v28, v29
    v_cvt_pk_bf16_f32 v207, v30, v31
    ds_write_b128 v86, v[204:207] offset:7168
    v_accvgpr_read_b32 v0, a64
    v_accvgpr_read_b32 v1, a65
    v_accvgpr_read_b32 v2, a66
    v_accvgpr_read_b32 v3, a67
    v_accvgpr_read_b32 v4, a68
    v_accvgpr_read_b32 v5, a69
    v_accvgpr_read_b32 v6, a70
    v_accvgpr_read_b32 v7, a71
    v_pk_mul_f32 v[0:1], v[0:1], v[68:69] op_sel_hi:[1,0]
    v_pk_mul_f32 v[2:3], v[2:3], v[68:69] op_sel_hi:[1,0]
    v_pk_mul_f32 v[4:5], v[4:5], v[68:69] op_sel_hi:[1,0]
    v_pk_mul_f32 v[6:7], v[6:7], v[68:69] op_sel_hi:[1,0]
    v_cvt_pk_bf16_f32 v208, v0, v1
    v_cvt_pk_bf16_f32 v209, v2, v3
    v_cvt_pk_bf16_f32 v210, v4, v5
    v_cvt_pk_bf16_f32 v211, v6, v7
    ds_write_b128 v86, v[208:211] offset:8192
    v_accvgpr_read_b32 v8, a72
    v_accvgpr_read_b32 v9, a73
    v_accvgpr_read_b32 v10, a74
    v_accvgpr_read_b32 v11, a75
    v_accvgpr_read_b32 v12, a76
    v_accvgpr_read_b32 v13, a77
    v_accvgpr_read_b32 v14, a78
    v_accvgpr_read_b32 v15, a79
    v_pk_mul_f32 v[8:9], v[8:9], v[68:69] op_sel_hi:[1,0]
    v_pk_mul_f32 v[10:11], v[10:11], v[68:69] op_sel_hi:[1,0]
    v_pk_mul_f32 v[12:13], v[12:13], v[68:69] op_sel_hi:[1,0]
    v_pk_mul_f32 v[14:15], v[14:15], v[68:69] op_sel_hi:[1,0]
    v_cvt_pk_bf16_f32 v212, v8, v9
    v_cvt_pk_bf16_f32 v213, v10, v11
    v_cvt_pk_bf16_f32 v214, v12, v13
    v_cvt_pk_bf16_f32 v215, v14, v15
    ds_write_b128 v86, v[212:215] offset:9216
    v_accvgpr_read_b32 v16, a80
    v_accvgpr_read_b32 v17, a81
    v_accvgpr_read_b32 v18, a82
    v_accvgpr_read_b32 v19, a83
    v_accvgpr_read_b32 v20, a84
    v_accvgpr_read_b32 v21, a85
    v_accvgpr_read_b32 v22, a86
    v_accvgpr_read_b32 v23, a87
    v_pk_mul_f32 v[16:17], v[16:17], v[68:69] op_sel_hi:[1,0]
    v_pk_mul_f32 v[18:19], v[18:19], v[68:69] op_sel_hi:[1,0]
    v_pk_mul_f32 v[20:21], v[20:21], v[68:69] op_sel_hi:[1,0]
    v_pk_mul_f32 v[22:23], v[22:23], v[68:69] op_sel_hi:[1,0]
    v_cvt_pk_bf16_f32 v216, v16, v17
    v_cvt_pk_bf16_f32 v217, v18, v19
    v_cvt_pk_bf16_f32 v218, v20, v21
    v_cvt_pk_bf16_f32 v219, v22, v23
    ds_write_b128 v86, v[216:219] offset:10240
    v_accvgpr_read_b32 v24, a88
    v_accvgpr_read_b32 v25, a89
    v_accvgpr_read_b32 v26, a90
    v_accvgpr_read_b32 v27, a91
    v_accvgpr_read_b32 v28, a92
    v_accvgpr_read_b32 v29, a93
    v_accvgpr_read_b32 v30, a94
    v_accvgpr_read_b32 v31, a95
    v_pk_mul_f32 v[24:25], v[24:25], v[68:69] op_sel_hi:[1,0]
    v_pk_mul_f32 v[26:27], v[26:27], v[68:69] op_sel_hi:[1,0]
    v_pk_mul_f32 v[28:29], v[28:29], v[68:69] op_sel_hi:[1,0]
    v_pk_mul_f32 v[30:31], v[30:31], v[68:69] op_sel_hi:[1,0]
    v_cvt_pk_bf16_f32 v220, v24, v25
    v_cvt_pk_bf16_f32 v221, v26, v27
    v_cvt_pk_bf16_f32 v222, v28, v29
    v_cvt_pk_bf16_f32 v223, v30, v31
    ds_write_b128 v86, v[220:223] offset:11264
    s_waitcnt vmcnt(8)
    s_barrier
    v_accvgpr_read_b32 v0, a96
    v_accvgpr_read_b32 v1, a97
    v_accvgpr_read_b32 v2, a98
    v_accvgpr_read_b32 v3, a99
    v_accvgpr_read_b32 v4, a100
    v_accvgpr_read_b32 v5, a101
    v_accvgpr_read_b32 v6, a102
    v_accvgpr_read_b32 v7, a103
    ds_read_b64_tr_b16 a[160:161], v84 offset:0
    ds_read_b64_tr_b16 a[162:163], v84 offset:2048
    ds_read_b64_tr_b16 a[164:165], v84 offset:8
    ds_read_b64_tr_b16 a[166:167], v84 offset:2056
    v_pk_mul_f32 v[0:1], v[0:1], v[70:71] op_sel_hi:[1,0]
    v_pk_mul_f32 v[2:3], v[2:3], v[70:71] op_sel_hi:[1,0]
    v_pk_mul_f32 v[4:5], v[4:5], v[70:71] op_sel_hi:[1,0]
    v_pk_mul_f32 v[6:7], v[6:7], v[70:71] op_sel_hi:[1,0]
    v_cvt_pk_bf16_f32 v224, v0, v1
    v_cvt_pk_bf16_f32 v225, v2, v3
    v_cvt_pk_bf16_f32 v226, v4, v5
    v_cvt_pk_bf16_f32 v227, v6, v7
    ds_write_b128 v86, v[224:227] offset:12288
    v_accvgpr_read_b32 v8, a104
    v_accvgpr_read_b32 v9, a105
    v_accvgpr_read_b32 v10, a106
    v_accvgpr_read_b32 v11, a107
    v_accvgpr_read_b32 v12, a108
    v_accvgpr_read_b32 v13, a109
    v_accvgpr_read_b32 v14, a110
    v_accvgpr_read_b32 v15, a111
    ds_read_b64_tr_b16 a[168:169], v84 offset:4096
    ds_read_b64_tr_b16 a[170:171], v84 offset:6144
    ds_read_b64_tr_b16 a[172:173], v84 offset:4104
    ds_read_b64_tr_b16 a[174:175], v84 offset:6152
    v_pk_mul_f32 v[8:9], v[8:9], v[70:71] op_sel_hi:[1,0]
    v_pk_mul_f32 v[10:11], v[10:11], v[70:71] op_sel_hi:[1,0]
    v_pk_mul_f32 v[12:13], v[12:13], v[70:71] op_sel_hi:[1,0]
    v_pk_mul_f32 v[14:15], v[14:15], v[70:71] op_sel_hi:[1,0]
    v_cvt_pk_bf16_f32 v228, v8, v9
    v_cvt_pk_bf16_f32 v229, v10, v11
    v_cvt_pk_bf16_f32 v230, v12, v13
    v_cvt_pk_bf16_f32 v231, v14, v15
    ds_write_b128 v86, v[228:231] offset:13312
    v_accvgpr_read_b32 v16, a112
    v_accvgpr_read_b32 v17, a113
    v_accvgpr_read_b32 v18, a114
    v_accvgpr_read_b32 v19, a115
    v_accvgpr_read_b32 v20, a116
    v_accvgpr_read_b32 v21, a117
    v_accvgpr_read_b32 v22, a118
    v_accvgpr_read_b32 v23, a119
    ds_read_b64_tr_b16 a[176:177], v84 offset:8192
    ds_read_b64_tr_b16 a[178:179], v84 offset:10240
    ds_read_b64_tr_b16 a[180:181], v84 offset:8200
    ds_read_b64_tr_b16 a[182:183], v84 offset:10248
    v_pk_mul_f32 v[16:17], v[16:17], v[70:71] op_sel_hi:[1,0]
    v_pk_mul_f32 v[18:19], v[18:19], v[70:71] op_sel_hi:[1,0]
    v_pk_mul_f32 v[20:21], v[20:21], v[70:71] op_sel_hi:[1,0]
    v_pk_mul_f32 v[22:23], v[22:23], v[70:71] op_sel_hi:[1,0]
    v_cvt_pk_bf16_f32 v232, v16, v17
    v_cvt_pk_bf16_f32 v233, v18, v19
    v_cvt_pk_bf16_f32 v234, v20, v21
    v_cvt_pk_bf16_f32 v235, v22, v23
    ds_write_b128 v86, v[232:235] offset:14336
    v_accvgpr_read_b32 v24, a120
    v_accvgpr_read_b32 v25, a121
    v_accvgpr_read_b32 v26, a122
    v_accvgpr_read_b32 v27, a123
    v_accvgpr_read_b32 v28, a124
    v_accvgpr_read_b32 v29, a125
    v_accvgpr_read_b32 v30, a126
    v_accvgpr_read_b32 v31, a127
    ds_read_b64_tr_b16 a[184:185], v84 offset:12288
    ds_read_b64_tr_b16 a[186:187], v84 offset:14336
    ds_read_b64_tr_b16 a[188:189], v84 offset:12296
    ds_read_b64_tr_b16 a[190:191], v84 offset:14344
    v_pk_mul_f32 v[24:25], v[24:25], v[70:71] op_sel_hi:[1,0]
    v_pk_mul_f32 v[26:27], v[26:27], v[70:71] op_sel_hi:[1,0]
    v_pk_mul_f32 v[28:29], v[28:29], v[70:71] op_sel_hi:[1,0]
    v_pk_mul_f32 v[30:31], v[30:31], v[70:71] op_sel_hi:[1,0]
    v_cvt_pk_bf16_f32 v236, v24, v25
    v_cvt_pk_bf16_f32 v237, v26, v27
    v_cvt_pk_bf16_f32 v238, v28, v29
    v_cvt_pk_bf16_f32 v239, v30, v31
    ds_write_b128 v86, v[236:239] offset:15360
    v_accvgpr_read_b32 v0, a128
    v_accvgpr_read_b32 v1, a129
    v_accvgpr_read_b32 v2, a130
    v_accvgpr_read_b32 v3, a131
    v_accvgpr_read_b32 v4, a132
    v_accvgpr_read_b32 v5, a133
    v_accvgpr_read_b32 v6, a134
    v_accvgpr_read_b32 v7, a135
    ds_read_b64_tr_b16 a[192:193], v94 offset:0
    ds_read_b64_tr_b16 a[194:195], v94 offset:2048
    ds_read_b64_tr_b16 a[196:197], v94 offset:8
    ds_read_b64_tr_b16 a[198:199], v94 offset:2056
    v_pk_mul_f32 v[0:1], v[0:1], v[72:73] op_sel_hi:[1,0]
    v_pk_mul_f32 v[2:3], v[2:3], v[72:73] op_sel_hi:[1,0]
    v_pk_mul_f32 v[4:5], v[4:5], v[72:73] op_sel_hi:[1,0]
    v_pk_mul_f32 v[6:7], v[6:7], v[72:73] op_sel_hi:[1,0]
    v_cvt_pk_bf16_f32 v240, v0, v1
    v_cvt_pk_bf16_f32 v241, v2, v3
    v_cvt_pk_bf16_f32 v242, v4, v5
    v_cvt_pk_bf16_f32 v243, v6, v7
    ds_write_b128 v86, v[240:243] offset:16384
    v_accvgpr_read_b32 v8, a136
    v_accvgpr_read_b32 v9, a137
    v_accvgpr_read_b32 v10, a138
    v_accvgpr_read_b32 v11, a139
    v_accvgpr_read_b32 v12, a140
    v_accvgpr_read_b32 v13, a141
    v_accvgpr_read_b32 v14, a142
    v_accvgpr_read_b32 v15, a143
    ds_read_b64_tr_b16 a[200:201], v94 offset:4096
    ds_read_b64_tr_b16 a[202:203], v94 offset:6144
    ds_read_b64_tr_b16 a[204:205], v94 offset:4104
    ds_read_b64_tr_b16 a[206:207], v94 offset:6152
    v_pk_mul_f32 v[8:9], v[8:9], v[72:73] op_sel_hi:[1,0]
    v_pk_mul_f32 v[10:11], v[10:11], v[72:73] op_sel_hi:[1,0]
    v_pk_mul_f32 v[12:13], v[12:13], v[72:73] op_sel_hi:[1,0]
    v_pk_mul_f32 v[14:15], v[14:15], v[72:73] op_sel_hi:[1,0]
    v_cvt_pk_bf16_f32 v244, v8, v9
    v_cvt_pk_bf16_f32 v245, v10, v11
    v_cvt_pk_bf16_f32 v246, v12, v13
    v_cvt_pk_bf16_f32 v247, v14, v15
    ds_write_b128 v86, v[244:247] offset:17408
    v_accvgpr_read_b32 v16, a144
    v_accvgpr_read_b32 v17, a145
    v_accvgpr_read_b32 v18, a146
    v_accvgpr_read_b32 v19, a147
    v_accvgpr_read_b32 v20, a148
    v_accvgpr_read_b32 v21, a149
    v_accvgpr_read_b32 v22, a150
    v_accvgpr_read_b32 v23, a151
    ds_read_b64_tr_b16 a[208:209], v94 offset:8192
    ds_read_b64_tr_b16 a[210:211], v94 offset:10240
    ds_read_b64_tr_b16 a[212:213], v94 offset:8200
    ds_read_b64_tr_b16 a[214:215], v94 offset:10248
    v_pk_mul_f32 v[16:17], v[16:17], v[72:73] op_sel_hi:[1,0]
    v_pk_mul_f32 v[18:19], v[18:19], v[72:73] op_sel_hi:[1,0]
    v_pk_mul_f32 v[20:21], v[20:21], v[72:73] op_sel_hi:[1,0]
    v_pk_mul_f32 v[22:23], v[22:23], v[72:73] op_sel_hi:[1,0]
    v_cvt_pk_bf16_f32 v248, v16, v17
    v_cvt_pk_bf16_f32 v249, v18, v19
    v_cvt_pk_bf16_f32 v250, v20, v21
    v_cvt_pk_bf16_f32 v251, v22, v23
    ds_write_b128 v86, v[248:251] offset:18432
    v_accvgpr_read_b32 v24, a152
    v_accvgpr_read_b32 v25, a153
    v_accvgpr_read_b32 v26, a154
    v_accvgpr_read_b32 v27, a155
    v_accvgpr_read_b32 v28, a156
    v_accvgpr_read_b32 v29, a157
    v_accvgpr_read_b32 v30, a158
    v_accvgpr_read_b32 v31, a159
    ds_read_b64_tr_b16 a[216:217], v94 offset:12288
    ds_read_b64_tr_b16 a[218:219], v94 offset:14336
    ds_read_b64_tr_b16 a[220:221], v94 offset:12296
    ds_read_b64_tr_b16 a[222:223], v94 offset:14344
    v_pk_mul_f32 v[24:25], v[24:25], v[72:73] op_sel_hi:[1,0]
    v_pk_mul_f32 v[26:27], v[26:27], v[72:73] op_sel_hi:[1,0]
    v_pk_mul_f32 v[28:29], v[28:29], v[72:73] op_sel_hi:[1,0]
    v_pk_mul_f32 v[30:31], v[30:31], v[72:73] op_sel_hi:[1,0]
    v_cvt_pk_bf16_f32 v252, v24, v25
    v_cvt_pk_bf16_f32 v253, v26, v27
    v_cvt_pk_bf16_f32 v254, v28, v29
    v_cvt_pk_bf16_f32 v255, v30, v31
    ds_write_b128 v86, v[252:255] offset:19456
    s_waitcnt vmcnt(0) lgkmcnt(0)
    s_barrier
    v_mov_b32 v90, 163776
    ds_read_b128 v[32:35], v90
    ds_read_b128 a[0:3], v87 offset:0
    ds_read_b128 a[4:7], v87 offset:1024
    ds_read_b128 a[8:11], v87 offset:2048
    ds_read_b128 a[12:15], v87 offset:3072
    ds_read_b128 a[16:19], v87 offset:4096
    ds_read_b128 a[20:23], v87 offset:5120
    ds_read_b128 a[24:27], v87 offset:6144
    ds_read_b128 a[28:31], v87 offset:7168
    ds_read_b128 a[32:35], v87 offset:8192
    ds_read_b128 a[36:39], v87 offset:9216
    ds_read_b128 a[40:43], v87 offset:10240
    ds_read_b128 a[44:47], v87 offset:11264
    s_waitcnt lgkmcnt(12)
    ds_read_b128 a[48:51], v87 offset:12288
    ds_read_b128 a[52:55], v87 offset:13312
    ds_read_b128 a[56:59], v87 offset:14336
    ds_read_b128 a[60:63], v87 offset:15360
    ds_read_b128 a[64:67], v87 offset:16384
    ds_read_b128 a[68:71], v87 offset:17408
    ds_read_b128 a[72:75], v87 offset:18432
    ds_read_b128 a[76:79], v87 offset:19456
    v_or_b32 v32, v32, v33
    v_or_b32 v34, v34, v35
    v_or_b32 v32, v32, v34
    s_nop 0
    v_readfirstlane_b32 s75, v32
    s_cmp_eq_u32 s72, 0
    s_cselect_b32 s75, s75, 0
    s_cmp_lg_u32 s75, 0
    s_cbranch_scc1 L_fallback
    s_mov_b32 s60, 5
    s_mov_b32 s67, 65536
    v_add_u32 v81, 0x8000, v84
    v_add_u32 v82, 0x8000, v94
    s_branch L_op_first
L_op:
    s_waitcnt lgkmcnt(2)
L_op_first:
    v_mfma_f32_16x16x32_bf16 v[0:3], a[160:163], v[176:179], 0
    v_mfma_f32_16x16x32_bf16 v[8:11], a[160:163], v[192:195], 0
    v_mfma_f32_16x16x32_bf16 v[16:19], a[160:163], v[208:211], 0
    v_mfma_f32_16x16x32_bf16 v[24:27], a[160:163], v[224:227], 0
    v_mfma_f32_16x16x32_bf16 v[32:35], a[160:163], v[240:243], 0
    s_waitcnt vmcnt(5) lgkmcnt(0)
    s_barrier
    v_mfma_f32_16x16x32_bf16 v[4:7], a[164:167], v[176:179], 0
    ds_read_b64_tr_b16 a[160:161], v81 offset:0
    s_add_u32 s62, s67, s65
    v_mfma_f32_16x16x32_bf16 v[12:15], a[164:167], v[192:195], 0
    ds_read_b64_tr_b16 a[162:163], v81 offset:2048
    s_add_u32 m0, s62, 0
    v_mfma_f32_16x16x32_bf16 v[20:23], a[164:167], v[208:211], 0
    s_mov_b32 s61, s64
    buffer_load_dwordx4 v85, s[24:27], s61 offen lds
    v_mfma_f32_16x16x32_bf16 v[28:31], a[164:167], v[224:227], 0
    v_mfma_f32_16x16x32_bf16 v[36:39], a[164:167], v[240:243], 0
    s_add_u32 m0, s62, 1024
    s_add_u32 s61, s64, 9216
    v_mfma_f32_16x16x32_bf16 v[0:3], a[168:171], v[180:183], v[0:3]
    ds_read_b64_tr_b16 a[164:165], v81 offset:8
    buffer_load_dwordx4 v85, s[24:27], s61 offen lds
    v_mfma_f32_16x16x32_bf16 v[8:11], a[168:171], v[196:199], v[8:11]
    ds_read_b64_tr_b16 a[166:167], v81 offset:2056
    v_mfma_f32_16x16x32_bf16 v[16:19], a[168:171], v[212:215], v[16:19]
    s_add_u32 m0, s62, 2048
    s_add_u32 s61, s64, 18432
    v_mfma_f32_16x16x32_bf16 v[24:27], a[168:171], v[228:231], v[24:27]
    buffer_load_dwordx4 v85, s[24:27], s61 offen lds
    v_cvt_pk_bf16_f32 v96, v40, v41
    v_mfma_f32_16x16x32_bf16 v[32:35], a[168:171], v[244:247], v[32:35]
    v_cvt_pk_bf16_f32 v97, v42, v43
    v_cvt_pk_bf16_f32 v98, v44, v45
    v_mfma_f32_16x16x32_bf16 v[4:7], a[172:175], v[180:183], v[4:7]
    ds_read_b64_tr_b16 a[168:169], v81 offset:4096
    s_add_u32 m0, s62, 3072
    v_mfma_f32_16x16x32_bf16 v[12:15], a[172:175], v[196:199], v[12:15]
    ds_read_b64_tr_b16 a[170:171], v81 offset:6144
    s_add_u32 s61, s64, 27648
    v_mfma_f32_16x16x32_bf16 v[20:23], a[172:175], v[212:215], v[20:23]
    buffer_load_dwordx4 v85, s[24:27], s61 offen lds
    v_cvt_pk_bf16_f32 v99, v46, v47
    v_mfma_f32_16x16x32_bf16 v[28:31], a[172:175], v[228:231], v[28:31]
    s_add_u32 m0, s62, 4096
    s_add_u32 s61, s64, 36864
    v_mfma_f32_16x16x32_bf16 v[36:39], a[172:175], v[244:247], v[36:39]
    buffer_load_dwordx4 v85, s[24:27], s61 offen lds
    v_cvt_pk_bf16_f32 v100, v48, v49
    v_mfma_f32_16x16x32_bf16 v[0:3], a[176:179], v[184:187], v[0:3]
    ds_read_b64_tr_b16 a[172:173], v81 offset:4104
    v_cvt_pk_bf16_f32 v101, v50, v51
    v_mfma_f32_16x16x32_bf16 v[8:11], a[176:179], v[200:203], v[8:11]
    ds_read_b64_tr_b16 a[174:175], v81 offset:6152
    s_add_u32 m0, s62, 5120
    v_mfma_f32_16x16x32_bf16 v[16:19], a[176:179], v[216:219], v[16:19]
    s_add_u32 s61, s64, 46080
    buffer_load_dwordx4 v85, s[24:27], s61 offen lds
    v_mfma_f32_16x16x32_bf16 v[24:27], a[176:179], v[232:235], v[24:27]
    v_cvt_pk_bf16_f32 v102, v52, v53
    v_cvt_pk_bf16_f32 v103, v54, v55
    v_mfma_f32_16x16x32_bf16 v[32:35], a[176:179], v[248:251], v[32:35]
    s_add_u32 m0, s62, 6144
    s_add_u32 s61, s64, 55296
    v_mfma_f32_16x16x32_bf16 v[4:7], a[180:183], v[184:187], v[4:7]
    ds_read_b64_tr_b16 a[176:177], v81 offset:8192
    buffer_load_dwordx4 v85, s[24:27], s61 offen lds
    v_mfma_f32_16x16x32_bf16 v[12:15], a[180:183], v[200:203], v[12:15]
    ds_read_b64_tr_b16 a[178:179], v81 offset:10240
    v_cvt_pk_bf16_f32 v104, v56, v57
    v_mfma_f32_16x16x32_bf16 v[20:23], a[180:183], v[216:219], v[20:23]
    s_add_u32 m0, s62, 7168
    s_add_u32 s61, s64, 64512
    v_mfma_f32_16x16x32_bf16 v[28:31], a[180:183], v[232:235], v[28:31]
    buffer_load_dwordx4 v85, s[24:27], s61 offen lds
    v_cvt_pk_bf16_f32 v105, v58, v59
    v_mfma_f32_16x16x32_bf16 v[36:39], a[180:183], v[248:251], v[36:39]
    v_cvt_pk_bf16_f32 v106, v60, v61
    v_cvt_pk_bf16_f32 v107, v62, v63
    v_mfma_f32_16x16x32_bf16 v[0:3], a[184:187], v[188:191], v[0:3]
    ds_read_b64_tr_b16 a[180:181], v81 offset:8200
    v_cvt_pk_bf16_f32 v108, v64, v65
    v_mfma_f32_16x16x32_bf16 v[8:11], a[184:187], v[204:207], v[8:11]
    ds_read_b64_tr_b16 a[182:183], v81 offset:10248
    v_cvt_pk_bf16_f32 v109, v66, v67
    v_mfma_f32_16x16x32_bf16 v[16:19], a[184:187], v[220:223], v[16:19]
    v_cvt_pk_bf16_f32 v110, v68, v69
    v_cvt_pk_bf16_f32 v111, v70, v71
    v_mfma_f32_16x16x32_bf16 v[24:27], a[184:187], v[236:239], v[24:27]
    v_cvt_pk_bf16_f32 v112, v72, v73
    v_cvt_pk_bf16_f32 v113, v74, v75
    v_mfma_f32_16x16x32_bf16 v[32:35], a[184:187], v[252:255], v[32:35]
    v_cvt_pk_bf16_f32 v114, v76, v77
    v_cvt_pk_bf16_f32 v115, v78, v79
    v_mfma_f32_16x16x32_bf16 v[4:7], a[188:191], v[188:191], v[4:7]
    ds_read_b64_tr_b16 a[184:185], v81 offset:12288
    s_add_u32 s64, s64, 128
    v_mfma_f32_16x16x32_bf16 v[12:15], a[188:191], v[204:207], v[12:15]
    ds_read_b64_tr_b16 a[186:187], v81 offset:14336
    s_add_u32 s59, s59, 1
    v_mfma_f32_16x16x32_bf16 v[20:23], a[188:191], v[220:223], v[20:23]
    s_cmp_ge_u32 s59, 9
    s_cselect_b32 s64, 0x70000000, s64
    v_mfma_f32_16x16x32_bf16 v[28:31], a[188:191], v[236:239], v[28:31]
    s_add_u32 s67, s67, 0x8000
    s_and_b32 s67, s67, 0x1ffff
    v_mfma_f32_16x16x32_bf16 v[36:39], a[188:191], v[252:255], v[36:39]
    buffer_store_dwordx4 v[96:99], v88, s[20:23], s74 offen offset:0 sc1
    v_mfma_f32_16x16x32_bf16 v[0:3], a[192:195], a[0:3], v[0:3]
    ds_read_b64_tr_b16 a[188:189], v81 offset:12296
    v_mfma_f32_16x16x32_bf16 v[8:11], a[192:195], a[16:19], v[8:11]
    ds_read_b64_tr_b16 a[190:191], v81 offset:14344
    v_mfma_f32_16x16x32_bf16 v[16:19], a[192:195], a[32:35], v[16:19]
    v_mfma_f32_16x16x32_bf16 v[24:27], a[192:195], a[48:51], v[24:27]
    v_mfma_f32_16x16x32_bf16 v[32:35], a[192:195], a[64:67], v[32:35]
    buffer_store_dwordx4 v[100:103], v88, s[20:23], s74 offen offset:1024 sc1
    v_mfma_f32_16x16x32_bf16 v[4:7], a[196:199], a[0:3], v[4:7]
    ds_read_b64_tr_b16 a[192:193], v82 offset:0
    v_mfma_f32_16x16x32_bf16 v[12:15], a[196:199], a[16:19], v[12:15]
    ds_read_b64_tr_b16 a[194:195], v82 offset:2048
    v_mfma_f32_16x16x32_bf16 v[20:23], a[196:199], a[32:35], v[20:23]
    v_mfma_f32_16x16x32_bf16 v[28:31], a[196:199], a[48:51], v[28:31]
    v_mfma_f32_16x16x32_bf16 v[36:39], a[196:199], a[64:67], v[36:39]
    buffer_store_dwordx4 v[104:107], v88, s[20:23], s74 offen offset:2048 sc1
    v_mfma_f32_16x16x32_bf16 v[0:3], a[200:203], a[4:7], v[0:3]
    ds_read_b64_tr_b16 a[196:197], v82 offset:8
    v_mfma_f32_16x16x32_bf16 v[8:11], a[200:203], a[20:23], v[8:11]
    ds_read_b64_tr_b16 a[198:199], v82 offset:2056
    v_mfma_f32_16x16x32_bf16 v[16:19], a[200:203], a[36:39], v[16:19]
    v_mfma_f32_16x16x32_bf16 v[24:27], a[200:203], a[52:55], v[24:27]
    v_mfma_f32_16x16x32_bf16 v[32:35], a[200:203], a[68:71], v[32:35]
    buffer_store_dwordx4 v[108:111], v88, s[20:23], s74 offen offset:3072 sc1
    v_mfma_f32_16x16x32_bf16 v[4:7], a[204:207], a[4:7], v[4:7]
    ds_read_b64_tr_b16 a[200:201], v82 offset:4096
    v_mfma_f32_16x16x32_bf16 v[12:15], a[204:207], a[20:23], v[12:15]
    ds_read_b64_tr_b16 a[202:203], v82 offset:6144
    v_mfma_f32_16x16x32_bf16 v[20:23], a[204:207], a[36:39], v[20:23]
    v_mfma_f32_16x16x32_bf16 v[28:31], a[204:207], a[52:55], v[28:31]
    v_mfma_f32_16x16x32_bf16 v[36:39], a[204:207], a[68:71], v[36:39]
    s_add_u32 s63, s74, 4096
    buffer_store_dwordx4 v[112:115], v88, s[20:23], s63 offen offset:0 sc1
    v_mfma_f32_16x16x32_bf16 v[0:3], a[208:211], a[8:11], v[0:3]
    ds_read_b64_tr_b16 a[204:205], v82 offset:4104
    s_mov_b32 s74, s77
    v_mfma_f32_16x16x32_bf16 v[8:11], a[208:211], a[24:27], v[8:11]
    ds_read_b64_tr_b16 a[206:207], v82 offset:6152
    s_add_u32 s77, s77, 20480
    v_mfma_f32_16x16x32_bf16 v[16:19], a[208:211], a[40:43], v[16:19]
    v_mfma_f32_16x16x32_bf16 v[24:27], a[208:211], a[56:59], v[24:27]
    v_mfma_f32_16x16x32_bf16 v[32:35], a[208:211], a[72:75], v[32:35]
    v_mfma_f32_16x16x32_bf16 v[4:7], a[212:215], a[8:11], v[4:7]
    ds_read_b64_tr_b16 a[208:209], v82 offset:8192
    v_mfma_f32_16x16x32_bf16 v[12:15], a[212:215], a[24:27], v[12:15]
    ds_read_b64_tr_b16 a[210:211], v82 offset:10240
    v_mfma_f32_16x16x32_bf16 v[20:23], a[212:215], a[40:43], v[20:23]
    v_mfma_f32_16x16x32_bf16 v[28:31], a[212:215], a[56:59], v[28:31]
    v_mfma_f32_16x16x32_bf16 v[36:39], a[212:215], a[72:75], v[36:39]
    v_mfma_f32_16x16x32_bf16 v[0:3], a[216:219], a[12:15], v[0:3]
    ds_read_b64_tr_b16 a[212:213], v82 offset:8200
    v_mfma_f32_16x16x32_bf16 v[8:11], a[216:219], a[28:31], v[8:11]
    ds_read_b64_tr_b16 a[214:215], v82 offset:10248
    v_mfma_f32_16x16x32_bf16 v[16:19], a[216:219], a[44:47], v[16:19]
    v_mfma_f32_16x16x32_bf16 v[24:27], a[216:219], a[60:63], v[24:27]
    v_mfma_f32_16x16x32_bf16 v[32:35], a[216:219], a[76:79], v[32:35]
    v_mfma_f32_16x16x32_bf16 v[4:7], a[220:223], a[12:15], v[4:7]
    ds_read_b64_tr_b16 a[216:217], v82 offset:12288
    v_mfma_f32_16x16x32_bf16 v[12:15], a[220:223], a[28:31], v[12:15]
    ds_read_b64_tr_b16 a[218:219], v82 offset:14336
    v_mfma_f32_16x16x32_bf16 v[20:23], a[220:223], a[44:47], v[20:23]
    v_mfma_f32_16x16x32_bf16 v[28:31], a[220:223], a[60:63], v[28:31]
    v_mfma_f32_16x16x32_bf16 v[36:39], a[220:223], a[76:79], v[36:39]
    ds_read_b64_tr_b16 a[220:221], v82 offset:12296
    ds_read_b64_tr_b16 a[222:223], v82 offset:14344
    v_add_u32 v81, 0x8000, v81
    v_add_u32 v82, 0x8000, v82
    v_and_b32 v81, 0x1ffff, v81
    v_and_b32 v82, 0x1ffff, v82
    s_sub_u32 s60, s60, 1
    s_cmp_eq_u32 s60, 0
    s_cbranch_scc1 L_op_done
    s_waitcnt lgkmcnt(2)
    v_mfma_f32_16x16x32_bf16 v[40:43], a[160:163], v[176:179], 0
    v_mfma_f32_16x16x32_bf16 v[48:51], a[160:163], v[192:195], 0
    v_mfma_f32_16x16x32_bf16 v[56:59], a[160:163], v[208:211], 0
    v_mfma_f32_16x16x32_bf16 v[64:67], a[160:163], v[224:227], 0
    v_mfma_f32_16x16x32_bf16 v[72:75], a[160:163], v[240:243], 0
    s_waitcnt vmcnt(5) lgkmcnt(0)
    s_barrier
    v_mfma_f32_16x16x32_bf16 v[44:47], a[164:167], v[176:179], 0
    ds_read_b64_tr_b16 a[160:161], v81 offset:0
    s_add_u32 s62, s67, s65
    v_mfma_f32_16x16x32_bf16 v[52:55], a[164:167], v[192:195], 0
    ds_read_b64_tr_b16 a[162:163], v81 offset:2048
    s_add_u32 m0, s62, 0
    v_mfma_f32_16x16x32_bf16 v[60:63], a[164:167], v[208:211], 0
    s_mov_b32 s61, s64
    buffer_load_dwordx4 v85, s[24:27], s61 offen lds
    v_mfma_f32_16x16x32_bf16 v[68:71], a[164:167], v[224:227], 0
    v_mfma_f32_16x16x32_bf16 v[76:79], a[164:167], v[240:243], 0
    s_add_u32 m0, s62, 1024
    s_add_u32 s61, s64, 9216
    v_mfma_f32_16x16x32_bf16 v[40:43], a[168:171], v[180:183], v[40:43]
    ds_read_b64_tr_b16 a[164:165], v81 offset:8
    buffer_load_dwordx4 v85, s[24:27], s61 offen lds
    v_mfma_f32_16x16x32_bf16 v[48:51], a[168:171], v[196:199], v[48:51]
    ds_read_b64_tr_b16 a[166:167], v81 offset:2056
    v_mfma_f32_16x16x32_bf16 v[56:59], a[168:171], v[212:215], v[56:59]
    s_add_u32 m0, s62, 2048
    s_add_u32 s61, s64, 18432
    v_mfma_f32_16x16x32_bf16 v[64:67], a[168:171], v[228:231], v[64:67]
    buffer_load_dwordx4 v85, s[24:27], s61 offen lds
    v_cvt_pk_bf16_f32 v96, v0, v1
    v_mfma_f32_16x16x32_bf16 v[72:75], a[168:171], v[244:247], v[72:75]
    v_cvt_pk_bf16_f32 v97, v2, v3
    v_cvt_pk_bf16_f32 v98, v4, v5
    v_mfma_f32_16x16x32_bf16 v[44:47], a[172:175], v[180:183], v[44:47]
    ds_read_b64_tr_b16 a[168:169], v81 offset:4096
    s_add_u32 m0, s62, 3072
    v_mfma_f32_16x16x32_bf16 v[52:55], a[172:175], v[196:199], v[52:55]
    ds_read_b64_tr_b16 a[170:171], v81 offset:6144
    s_add_u32 s61, s64, 27648
    v_mfma_f32_16x16x32_bf16 v[60:63], a[172:175], v[212:215], v[60:63]
    buffer_load_dwordx4 v85, s[24:27], s61 offen lds
    v_cvt_pk_bf16_f32 v99, v6, v7
    v_mfma_f32_16x16x32_bf16 v[68:71], a[172:175], v[228:231], v[68:71]
    s_add_u32 m0, s62, 4096
    s_add_u32 s61, s64, 36864
    v_mfma_f32_16x16x32_bf16 v[76:79], a[172:175], v[244:247], v[76:79]
    buffer_load_dwordx4 v85, s[24:27], s61 offen lds
    v_cvt_pk_bf16_f32 v100, v8, v9
    v_mfma_f32_16x16x32_bf16 v[40:43], a[176:179], v[184:187], v[40:43]
    ds_read_b64_tr_b16 a[172:173], v81 offset:4104
    v_cvt_pk_bf16_f32 v101, v10, v11
    v_mfma_f32_16x16x32_bf16 v[48:51], a[176:179], v[200:203], v[48:51]
    ds_read_b64_tr_b16 a[174:175], v81 offset:6152
    s_add_u32 m0, s62, 5120
    v_mfma_f32_16x16x32_bf16 v[56:59], a[176:179], v[216:219], v[56:59]
    s_add_u32 s61, s64, 46080
    buffer_load_dwordx4 v85, s[24:27], s61 offen lds
    v_mfma_f32_16x16x32_bf16 v[64:67], a[176:179], v[232:235], v[64:67]
    v_cvt_pk_bf16_f32 v102, v12, v13
    v_cvt_pk_bf16_f32 v103, v14, v15
    v_mfma_f32_16x16x32_bf16 v[72:75], a[176:179], v[248:251], v[72:75]
    s_add_u32 m0, s62, 6144
    s_add_u32 s61, s64, 55296
    v_mfma_f32_16x16x32_bf16 v[44:47], a[180:183], v[184:187], v[44:47]
    ds_read_b64_tr_b16 a[176:177], v81 offset:8192
    buffer_load_dwordx4 v85, s[24:27], s61 offen lds
    v_mfma_f32_16x16x32_bf16 v[52:55], a[180:183], v[200:203], v[52:55]
    ds_read_b64_tr_b16 a[178:179], v81 offset:10240
    v_cvt_pk_bf16_f32 v104, v16, v17
    v_mfma_f32_16x16x32_bf16 v[60:63], a[180:183], v[216:219], v[60:63]
    s_add_u32 m0, s62, 7168
    s_add_u32 s61, s64, 64512
    v_mfma_f32_16x16x32_bf16 v[68:71], a[180:183], v[232:235], v[68:71]
    buffer_load_dwordx4 v85, s[24:27], s61 offen lds
    v_cvt_pk_bf16_f32 v105, v18, v19
    v_mfma_f32_16x16x32_bf16 v[76:79], a[180:183], v[248:251], v[76:79]
    v_cvt_pk_bf16_f32 v106, v20, v21
    v_cvt_pk_bf16_f32 v107, v22, v23
    v_mfma_f32_16x16x32_bf16 v[40:43], a[184:187], v[188:191], v[40:43]
    ds_read_b64_tr_b16 a[180:181], v81 offset:8200
    v_cvt_pk_bf16_f32 v108, v24, v25
    v_mfma_f32_16x16x32_bf16 v[48:51], a[184:187], v[204:207], v[48:51]
    ds_read_b64_tr_b16 a[182:183], v81 offset:10248
    v_cvt_pk_bf16_f32 v109, v26, v27
    v_mfma_f32_16x16x32_bf16 v[56:59], a[184:187], v[220:223], v[56:59]
    v_cvt_pk_bf16_f32 v110, v28, v29
    v_cvt_pk_bf16_f32 v111, v30, v31
    v_mfma_f32_16x16x32_bf16 v[64:67], a[184:187], v[236:239], v[64:67]
    v_cvt_pk_bf16_f32 v112, v32, v33
    v_cvt_pk_bf16_f32 v113, v34, v35
    v_mfma_f32_16x16x32_bf16 v[72:75], a[184:187], v[252:255], v[72:75]
    v_cvt_pk_bf16_f32 v114, v36, v37
    v_cvt_pk_bf16_f32 v115, v38, v39
    v_mfma_f32_16x16x32_bf16 v[44:47], a[188:191], v[188:191], v[44:47]
    ds_read_b64_tr_b16 a[184:185], v81 offset:12288
    s_add_u32 s64, s64, 128
    v_mfma_f32_16x16x32_bf16 v[52:55], a[188:191], v[204:207], v[52:55]
    ds_read_b64_tr_b16 a[186:187], v81 offset:14336
    s_add_u32 s59, s59, 1
    v_mfma_f32_16x16x32_bf16 v[60:63], a[188:191], v[220:223], v[60:63]
    s_cmp_ge_u32 s59, 9
    s_cselect_b32 s64, 0x70000000, s64
    v_mfma_f32_16x16x32_bf16 v[68:71], a[188:191], v[236:239], v[68:71]
    s_add_u32 s67, s67, 0x8000
    s_and_b32 s67, s67, 0x1ffff
    v_mfma_f32_16x16x32_bf16 v[76:79], a[188:191], v[252:255], v[76:79]
    buffer_store_dwordx4 v[96:99], v88, s[20:23], s74 offen offset:0 sc1
    v_mfma_f32_16x16x32_bf16 v[40:43], a[192:195], a[0:3], v[40:43]
    ds_read_b64_tr_b16 a[188:189], v81 offset:12296
    v_mfma_f32_16x16x32_bf16 v[48:51], a[192:195], a[16:19], v[48:51]
    ds_read_b64_tr_b16 a[190:191], v81 offset:14344
    v_mfma_f32_16x16x32_bf16 v[56:59], a[192:195], a[32:35], v[56:59]
    v_mfma_f32_16x16x32_bf16 v[64:67], a[192:195], a[48:51], v[64:67]
    v_mfma_f32_16x16x32_bf16 v[72:75], a[192:195], a[64:67], v[72:75]
    buffer_store_dwordx4 v[100:103], v88, s[20:23], s74 offen offset:1024 sc1
    v_mfma_f32_16x16x32_bf16 v[44:47], a[196:199], a[0:3], v[44:47]
    ds_read_b64_tr_b16 a[192:193], v82 offset:0
    v_mfma_f32_16x16x32_bf16 v[52:55], a[196:199], a[16:19], v[52:55]
    ds_read_b64_tr_b16 a[194:195], v82 offset:2048
    v_mfma_f32_16x16x32_bf16 v[60:63], a[196:199], a[32:35], v[60:63]
    v_mfma_f32_16x16x32_bf16 v[68:71], a[196:199], a[48:51], v[68:71]
    v_mfma_f32_16x16x32_bf16 v[76:79], a[196:199], a[64:67], v[76:79]
    buffer_store_dwordx4 v[104:107], v88, s[20:23], s74 offen offset:2048 sc1
    v_mfma_f32_16x16x32_bf16 v[40:43], a[200:203], a[4:7], v[40:43]
    ds_read_b64_tr_b16 a[196:197], v82 offset:8
    v_mfma_f32_16x16x32_bf16 v[48:51], a[200:203], a[20:23], v[48:51]
    ds_read_b64_tr_b16 a[198:199], v82 offset:2056
    v_mfma_f32_16x16x32_bf16 v[56:59], a[200:203], a[36:39], v[56:59]
    v_mfma_f32_16x16x32_bf16 v[64:67], a[200:203], a[52:55], v[64:67]
    v_mfma_f32_16x16x32_bf16 v[72:75], a[200:203], a[68:71], v[72:75]
    buffer_store_dwordx4 v[108:111], v88, s[20:23], s74 offen offset:3072 sc1
    v_mfma_f32_16x16x32_bf16 v[44:47], a[204:207], a[4:7], v[44:47]
    ds_read_b64_tr_b16 a[200:201], v82 offset:4096
    v_mfma_f32_16x16x32_bf16 v[52:55], a[204:207], a[20:23], v[52:55]
    ds_read_b64_tr_b16 a[202:203], v82 offset:6144
    v_mfma_f32_16x16x32_bf16 v[60:63], a[204:207], a[36:39], v[60:63]
    v_mfma_f32_16x16x32_bf16 v[68:71], a[204:207], a[52:55], v[68:71]
    v_mfma_f32_16x16x32_bf16 v[76:79], a[204:207], a[68:71], v[76:79]
    s_add_u32 s63, s74, 4096
    buffer_store_dwordx4 v[112:115], v88, s[20:23], s63 offen offset:0 sc1
    v_mfma_f32_16x16x32_bf16 v[40:43], a[208:211], a[8:11], v[40:43]
    ds_read_b64_tr_b16 a[204:205], v82 offset:4104
    s_mov_b32 s74, s77
    v_mfma_f32_16x16x32_bf16 v[48:51], a[208:211], a[24:27], v[48:51]
    ds_read_b64_tr_b16 a[206:207], v82 offset:6152
    s_add_u32 s77, s77, 20480
    v_mfma_f32_16x16x32_bf16 v[56:59], a[208:211], a[40:43], v[56:59]
    v_mfma_f32_16x16x32_bf16 v[64:67], a[208:211], a[56:59], v[64:67]
    v_mfma_f32_16x16x32_bf16 v[72:75], a[208:211], a[72:75], v[72:75]
    v_mfma_f32_16x16x32_bf16 v[44:47], a[212:215], a[8:11], v[44:47]
    ds_read_b64_tr_b16 a[208:209], v82 offset:8192
    v_mfma_f32_16x16x32_bf16 v[52:55], a[212:215], a[24:27], v[52:55]
    ds_read_b64_tr_b16 a[210:211], v82 offset:10240
    v_mfma_f32_16x16x32_bf16 v[60:63], a[212:215], a[40:43], v[60:63]
    v_mfma_f32_16x16x32_bf16 v[68:71], a[212:215], a[56:59], v[68:71]
    v_mfma_f32_16x16x32_bf16 v[76:79], a[212:215], a[72:75], v[76:79]
    v_mfma_f32_16x16x32_bf16 v[40:43], a[216:219], a[12:15], v[40:43]
    ds_read_b64_tr_b16 a[212:213], v82 offset:8200
    v_mfma_f32_16x16x32_bf16 v[48:51], a[216:219], a[28:31], v[48:51]
    ds_read_b64_tr_b16 a[214:215], v82 offset:10248
    v_mfma_f32_16x16x32_bf16 v[56:59], a[216:219], a[44:47], v[56:59]
    v_mfma_f32_16x16x32_bf16 v[64:67], a[216:219], a[60:63], v[64:67]
    v_mfma_f32_16x16x32_bf16 v[72:75], a[216:219], a[76:79], v[72:75]
    v_mfma_f32_16x16x32_bf16 v[44:47], a[220:223], a[12:15], v[44:47]
    ds_read_b64_tr_b16 a[216:217], v82 offset:12288
    v_mfma_f32_16x16x32_bf16 v[52:55], a[220:223], a[28:31], v[52:55]
    ds_read_b64_tr_b16 a[218:219], v82 offset:14336
    v_mfma_f32_16x16x32_bf16 v[60:63], a[220:223], a[44:47], v[60:63]
    v_mfma_f32_16x16x32_bf16 v[68:71], a[220:223], a[60:63], v[68:71]
    v_mfma_f32_16x16x32_bf16 v[76:79], a[220:223], a[76:79], v[76:79]
    ds_read_b64_tr_b16 a[220:221], v82 offset:12296
    ds_read_b64_tr_b16 a[222:223], v82 offset:14344
    v_add_u32 v81, 0x8000, v81
    v_add_u32 v82, 0x8000, v82
    v_and_b32 v81, 0x1ffff, v81
    v_and_b32 v82, 0x1ffff, v82
    s_branch L_op
L_op_done:
    s_nop 7
    v_cvt_pk_bf16_f32 v96, v0, v1
    v_cvt_pk_bf16_f32 v97, v2, v3
    v_cvt_pk_bf16_f32 v98, v4, v5
    v_cvt_pk_bf16_f32 v99, v6, v7
    v_cvt_pk_bf16_f32 v100, v8, v9
    v_cvt_pk_bf16_f32 v101, v10, v11
    v_cvt_pk_bf16_f32 v102, v12, v13
    v_cvt_pk_bf16_f32 v103, v14, v15
    v_cvt_pk_bf16_f32 v104, v16, v17
    v_cvt_pk_bf16_f32 v105, v18, v19
    v_cvt_pk_bf16_f32 v106, v20, v21
    v_cvt_pk_bf16_f32 v107, v22, v23
    v_cvt_pk_bf16_f32 v108, v24, v25
    v_cvt_pk_bf16_f32 v109, v26, v27
    v_cvt_pk_bf16_f32 v110, v28, v29
    v_cvt_pk_bf16_f32 v111, v30, v31
    v_cvt_pk_bf16_f32 v112, v32, v33
    v_cvt_pk_bf16_f32 v113, v34, v35
    v_cvt_pk_bf16_f32 v114, v36, v37
    v_cvt_pk_bf16_f32 v115, v38, v39
    buffer_store_dwordx4 v[96:99], v88, s[20:23], s74 offen offset:0 sc1
    buffer_store_dwordx4 v[100:103], v88, s[20:23], s74 offen offset:1024 sc1
    buffer_store_dwordx4 v[104:107], v88, s[20:23], s74 offen offset:2048 sc1
    buffer_store_dwordx4 v[108:111], v88, s[20:23], s74 offen offset:3072 sc1
    s_add_u32 s63, s74, 4096
    buffer_store_dwordx4 v[112:115], v88, s[20:23], s63 offen offset:0 sc1
    s_mov_b32 s74, s77
    s_add_u32 s77, s77, 20480
    s_endpgm
L_wot:
    s_and_b32 s61, s31, 3
    s_mul_i32 s61, s61, 294912
    s_sub_u32 s36, s24, s61
    s_subb_u32 s37, s25, 0
    s_mov_b32 s38, 1179648
    s_mov_b32 s39, 0x20000
    s_lshr_b32 s61, s2, 3
    s_lshl_b32 s61, s61, 2
    s_add_u32 s61, s61, s28
    s_mul_i32 s62, s61, 9216
    s_lshl_b32 s61, s28, 10
    s_add_u32 m0, s61, 153600
    v_lshlrev_b32 v252, 4, v80
    buffer_load_dwordx4 v252, s[36:39], s62 offen lds
    s_add_u32 s62, s62, 1024
    buffer_load_dwordx4 v252, s[36:39], s62 offen lds
    s_add_u32 s62, s62, 1024
    buffer_load_dwordx4 v252, s[36:39], s62 offen lds
    s_add_u32 s62, s62, 1024
    buffer_load_dwordx4 v252, s[36:39], s62 offen lds
    s_add_u32 s62, s62, 1024
    buffer_load_dwordx4 v252, s[36:39], s62 offen lds
    s_add_u32 s62, s62, 1024
    buffer_load_dwordx4 v252, s[36:39], s62 offen lds
    s_add_u32 s62, s62, 1024
    buffer_load_dwordx4 v252, s[36:39], s62 offen lds
    s_add_u32 s62, s62, 1024
    buffer_load_dwordx4 v252, s[36:39], s62 offen lds
    s_add_u32 s62, s62, 1024
    buffer_load_dwordx4 v252, s[36:39], s62 offen lds
    s_branch L_wot_back
L_fallback:
    s_waitcnt vmcnt(0) lgkmcnt(0)
    s_barrier
    v_and_b32 v81, 0x1fff, v81
    v_and_b32 v82, 0x1fff, v82
    v_mov_b32 v236, 0xff800000
    v_mov_b32 v237, 0xff800000
    v_mov_b32 v238, 0xff800000
    v_mov_b32 v239, 0xff800000
    v_mov_b32 v240, 0xff800000
    s_mov_b32 s63, 0
L_fb_loop:
    s_mov_b32 m0, s73
    s_nop 0
    buffer_load_dwordx4 v83, s[12:15], s63 offen nt lds
    buffer_load_dwordx4 v83, s[12:15], s63 offen offset:2048 nt lds
    s_waitcnt vmcnt(0)
    s_barrier
    ds_read_b128 a[160:163], v81 offset:0
    ds_read_b128 a[164:167], v81 offset:512
    ds_read_b128 a[168:171], v81 offset:1024
    ds_read_b128 a[172:175], v81 offset:1536
    ds_read_b128 a[176:179], v81 offset:4096
    ds_read_b128 a[180:183], v81 offset:4608
    ds_read_b128 a[184:187], v81 offset:5120
    ds_read_b128 a[188:191], v81 offset:5632
    s_waitcnt lgkmcnt(0)
    s_barrier
    v_mfma_f32_16x16x32_bf16 v[0:3], a[160:163], v[96:99], 0
    v_mfma_f32_16x16x32_bf16 v[4:7], a[160:163], v[112:115], 0
    v_mfma_f32_16x16x32_bf16 v[8:11], a[160:163], v[128:131], 0
    v_mfma_f32_16x16x32_bf16 v[12:15], a[160:163], v[144:147], 0
    v_mfma_f32_16x16x32_bf16 v[16:19], a[160:163], v[160:163], 0
    v_mfma_f32_16x16x32_bf16 v[0:3], a[164:167], v[100:103], v[0:3]
    v_mfma_f32_16x16x32_bf16 v[4:7], a[164:167], v[116:119], v[4:7]
    v_mfma_f32_16x16x32_bf16 v[8:11], a[164:167], v[132:135], v[8:11]
    v_mfma_f32_16x16x32_bf16 v[12:15], a[164:167], v[148:151], v[12:15]
    v_mfma_f32_16x16x32_bf16 v[16:19], a[164:167], v[164:167], v[16:19]
    v_mfma_f32_16x16x32_bf16 v[0:3], a[168:171], v[104:107], v[0:3]
    v_mfma_f32_16x16x32_bf16 v[4:7], a[168:171], v[120:123], v[4:7]
    v_mfma_f32_16x16x32_bf16 v[8:11], a[168:171], v[136:139], v[8:11]
    v_mfma_f32_16x16x32_bf16 v[12:15], a[168:171], v[152:155], v[12:15]
    v_mfma_f32_16x16x32_bf16 v[16:19], a[168:171], v[168:171], v[16:19]
    v_mfma_f32_16x16x32_bf16 v[0:3], a[172:175], v[108:111], v[0:3]
    v_mfma_f32_16x16x32_bf16 v[4:7], a[172:175], v[124:127], v[4:7]
    v_mfma_f32_16x16x32_bf16 v[8:11], a[172:175], v[140:143], v[8:11]
    v_mfma_f32_16x16x32_bf16 v[12:15], a[172:175], v[156:159], v[12:15]
    v_mfma_f32_16x16x32_bf16 v[16:19], a[172:175], v[172:175], v[16:19]
    v_mfma_f32_16x16x32_bf16 v[20:23], a[176:179], v[96:99], 0
    v_mfma_f32_16x16x32_bf16 v[24:27], a[176:179], v[112:115], 0
    v_mfma_f32_16x16x32_bf16 v[28:31], a[176:179], v[128:131], 0
    v_mfma_f32_16x16x32_bf16 v[32:35], a[176:179], v[144:147], 0
    v_mfma_f32_16x16x32_bf16 v[36:39], a[176:179], v[160:163], 0
    v_mfma_f32_16x16x32_bf16 v[20:23], a[180:183], v[100:103], v[20:23]
    v_mfma_f32_16x16x32_bf16 v[24:27], a[180:183], v[116:119], v[24:27]
    v_mfma_f32_16x16x32_bf16 v[28:31], a[180:183], v[132:135], v[28:31]
    v_mfma_f32_16x16x32_bf16 v[32:35], a[180:183], v[148:151], v[32:35]
    v_mfma_f32_16x16x32_bf16 v[36:39], a[180:183], v[164:167], v[36:39]
    v_mfma_f32_16x16x32_bf16 v[20:23], a[184:187], v[104:107], v[20:23]
    v_mfma_f32_16x16x32_bf16 v[24:27], a[184:187], v[120:123], v[24:27]
    v_mfma_f32_16x16x32_bf16 v[28:31], a[184:187], v[136:139], v[28:31]
    v_mfma_f32_16x16x32_bf16 v[32:35], a[184:187], v[152:155], v[32:35]
    v_mfma_f32_16x16x32_bf16 v[36:39], a[184:187], v[168:171], v[36:39]
    v_mfma_f32_16x16x32_bf16 v[20:23], a[188:191], v[108:111], v[20:23]
    v_mfma_f32_16x16x32_bf16 v[24:27], a[188:191], v[124:127], v[24:27]
    v_mfma_f32_16x16x32_bf16 v[28:31], a[188:191], v[140:143], v[28:31]
    v_mfma_f32_16x16x32_bf16 v[32:35], a[188:191], v[156:159], v[32:35]
    v_mfma_f32_16x16x32_bf16 v[36:39], a[188:191], v[172:175], v[36:39]
    s_nop 7
    v_max3_f32 v236, v236, v0, v1
    v_max3_f32 v236, v236, v2, v3
    v_max3_f32 v236, v236, v20, v21
    v_max3_f32 v236, v236, v22, v23
    v_max3_f32 v237, v237, v4, v5
    v_max3_f32 v237, v237, v6, v7
    v_max3_f32 v237, v237, v24, v25
    v_max3_f32 v237, v237, v26, v27
    v_max3_f32 v238, v238, v8, v9
    v_max3_f32 v238, v238, v10, v11
    v_max3_f32 v238, v238, v28, v29
    v_max3_f32 v238, v238, v30, v31
    v_max3_f32 v239, v239, v12, v13
    v_max3_f32 v239, v239, v14, v15
    v_max3_f32 v239, v239, v32, v33
    v_max3_f32 v239, v239, v34, v35
    v_max3_f32 v240, v240, v16, v17
    v_max3_f32 v240, v240, v18, v19
    v_max3_f32 v240, v240, v36, v37
    v_max3_f32 v240, v240, v38, v39
    s_add_u32 s63, s63, 8192
    s_cmp_lt_u32 s63, 262144
    s_cbranch_scc1 L_fb_loop
    v_mov_b32 v241, v236
    v_mov_b32 v242, v237
    v_mov_b32 v243, v238
    v_mov_b32 v244, v239
    v_mov_b32 v245, v240
    s_nop 1
    v_permlane32_swap_b32 v236, v241
    v_permlane32_swap_b32 v237, v242
    v_permlane32_swap_b32 v238, v243
    v_permlane32_swap_b32 v239, v244
    v_permlane32_swap_b32 v240, v245
    s_nop 1
    v_max_f32 v236, v236, v241
    v_max_f32 v237, v237, v242
    v_max_f32 v238, v238, v243
    v_max_f32 v239, v239, v244
    v_max_f32 v240, v240, v245
    v_mov_b32 v241, v236
    v_mov_b32 v242, v237
    v_mov_b32 v243, v238
    v_mov_b32 v244, v239
    v_mov_b32 v245, v240
    s_nop 1
    v_permlane16_swap_b32 v236, v241
    v_permlane16_swap_b32 v237, v242
    v_permlane16_swap_b32 v238, v243
    v_permlane16_swap_b32 v239, v244
    v_permlane16_swap_b32 v240, v245
    s_nop 1
    v_max_f32 v236, v236, v241
    v_max_f32 v237, v237, v242
    v_max_f32 v238, v238, v243
    v_max_f32 v239, v239, v244
    v_max_f32 v240, v240, v245
    v_mov_b32 v0, 0
    v_mov_b32 v1, 0
    v_mov_b32 v2, 0
    v_mov_b32 v3, 0
    s_nop 1
    v_mfma_f32_32x32x16_bf16 a[0:15], v[0:3], v[0:3], 0
    v_mfma_f32_32x32x16_bf16 a[16:31], v[0:3], v[0:3], 0
    v_mfma_f32_32x32x16_bf16 a[32:47], v[0:3], v[0:3], 0
    v_mfma_f32_32x32x16_bf16 a[48:63], v[0:3], v[0:3], 0
    v_mfma_f32_32x32x16_bf16 a[64:79], v[0:3], v[0:3], 0
    v_mfma_f32_32x32x16_bf16 a[80:95], v[0:3], v[0:3], 0
    v_mfma_f32_32x32x16_bf16 a[96:111], v[0:3], v[0:3], 0
    v_mfma_f32_32x32x16_bf16 a[112:127], v[0:3], v[0:3], 0
    v_mfma_f32_32x32x16_bf16 a[128:143], v[0:3], v[0:3], 0
    v_mfma_f32_32x32x16_bf16 a[144:159], v[0:3], v[0:3], 0
    v_mfma_f32_32x32x16_bf16 a[192:207], v[0:3], v[0:3], 0
    v_mfma_f32_32x32x16_bf16 a[208:223], v[0:3], v[0:3], 0
    v_mfma_f32_32x32x16_bf16 a[224:239], v[0:3], v[0:3], 0
    v_mfma_f32_16x16x32_bf16 a[240:243], v[0:3], v[0:3], 0
    s_mov_b32 s63, 0
    s_lshl_b32 s62, s63, 1
    s_add_u32 s62, s62, s73
    s_mov_b32 m0, s62
    s_nop 0
    buffer_load_dwordx4 v83, s[12:15], s63 offen nt lds
    buffer_load_dwordx4 v83, s[12:15], s63 offen offset:2048 nt lds
    s_add_u32 m0, s62, 8192
    s_nop 0
    buffer_load_dwordx4 v83, s[16:19], s63 offen nt lds
    buffer_load_dwordx4 v83, s[16:19], s63 offen offset:2048 nt lds
    s_add_u32 s63, s63, 8192
    s_lshl_b32 s62, s63, 1
    s_add_u32 s62, s62, s73
    s_mov_b32 m0, s62
    s_nop 0
    buffer_load_dwordx4 v83, s[12:15], s63 offen nt lds
    buffer_load_dwordx4 v83, s[12:15], s63 offen offset:2048 nt lds
    s_add_u32 m0, s62, 8192
    s_nop 0
    buffer_load_dwordx4 v83, s[16:19], s63 offen nt lds
    buffer_load_dwordx4 v83, s[16:19], s63 offen offset:2048 nt lds
    s_add_u32 s63, s63, 8192
    s_lshl_b32 s62, s63, 1
    s_add_u32 s62, s62, s73
    s_mov_b32 m0, s62
    s_nop 0
    buffer_load_dwordx4 v83, s[12:15], s63 offen nt lds
    buffer_load_dwordx4 v83, s[12:15], s63 offen offset:2048 nt lds
    s_add_u32 m0, s62, 8192
    s_nop 0
    buffer_load_dwordx4 v83, s[16:19], s63 offen nt lds
    buffer_load_dwordx4 v83, s[16:19], s63 offen offset:2048 nt lds
    s_add_u32 s63, s63, 8192
    s_lshl_b32 s62, s63, 1
    s_add_u32 s62, s62, s73
    s_mov_b32 m0, s62
    s_nop 0
    buffer_load_dwordx4 v83, s[12:15], s63 offen nt lds
    buffer_load_dwordx4 v83, s[12:15], s63 offen offset:2048 nt lds
    s_add_u32 m0, s62, 8192
    s_nop 0
    buffer_load_dwordx4 v83, s[16:19], s63 offen nt lds
    buffer_load_dwordx4 v83, s[16:19], s63 offen offset:2048 nt lds
    s_add_u32 s63, s63, 8192
    s_lshl_b32 s62, s63, 1
    s_add_u32 s62, s62, s73
    s_mov_b32 m0, s62
    s_nop 0
    buffer_load_dwordx4 v83, s[12:15], s63 offen nt lds
    buffer_load_dwordx4 v83, s[12:15], s63 offen offset:2048 nt lds
    s_add_u32 m0, s62, 8192
    s_nop 0
    buffer_load_dwordx4 v83, s[16:19], s63 offen nt lds
    buffer_load_dwordx4 v83, s[16:19], s63 offen offset:2048 nt lds
    s_add_u32 s63, s63, 8192
    s_lshl_b32 s62, s63, 1
    s_add_u32 s62, s62, s73
    s_mov_b32 m0, s62
    s_nop 0
    buffer_load_dwordx4 v83, s[12:15], s63 offen nt lds
    buffer_load_dwordx4 v83, s[12:15], s63 offen offset:2048 nt lds
    s_add_u32 s63, s63, 8192
    s_mov_b32 s72, 1
    s_waitcnt vmcnt(16)
    s_barrier
    ds_read_b128 a[160:163], v81 offset:0
    ds_read_b128 a[164:167], v81 offset:512
    ds_read_b128 a[168:171], v81 offset:1024
    ds_read_b128 a[172:175], v81 offset:1536
    ds_read_b128 a[176:179], v81 offset:4096
    ds_read_b128 a[180:183], v81 offset:4608
    ds_read_b128 a[184:187], v81 offset:5120
    ds_read_b128 a[188:191], v81 offset:5632
    s_waitcnt lgkmcnt(0)
    v_mfma_f32_16x16x32_bf16 v[0:3], a[160:163], v[96:99], 0
    v_mfma_f32_16x16x32_bf16 v[4:7], a[160:163], v[112:115], 0
    v_mfma_f32_16x16x32_bf16 v[8:11], a[160:163], v[128:131], 0
    v_mfma_f32_16x16x32_bf16 v[12:15], a[160:163], v[144:147], 0
    v_mfma_f32_16x16x32_bf16 v[16:19], a[160:163], v[160:163], 0
    ds_read_b128 a[160:163], v81 offset:16384
    v_mfma_f32_16x16x32_bf16 v[0:3], a[164:167], v[100:103], v[0:3]
    v_mfma_f32_16x16x32_bf16 v[4:7], a[164:167], v[116:119], v[4:7]
    v_mfma_f32_16x16x32_bf16 v[8:11], a[164:167], v[132:135], v[8:11]
    v_mfma_f32_16x16x32_bf16 v[12:15], a[164:167], v[148:151], v[12:15]
    v_mfma_f32_16x16x32_bf16 v[16:19], a[164:167], v[164:167], v[16:19]
    ds_read_b128 a[164:167], v81 offset:16896
    v_mfma_f32_16x16x32_bf16 v[0:3], a[168:171], v[104:107], v[0:3]
    v_mfma_f32_16x16x32_bf16 v[4:7], a[168:171], v[120:123], v[4:7]
    v_mfma_f32_16x16x32_bf16 v[8:11], a[168:171], v[136:139], v[8:11]
    v_mfma_f32_16x16x32_bf16 v[12:15], a[168:171], v[152:155], v[12:15]
    v_mfma_f32_16x16x32_bf16 v[16:19], a[168:171], v[168:171], v[16:19]
    ds_read_b128 a[168:171], v81 offset:17408
    v_mfma_f32_16x16x32_bf16 v[0:3], a[172:175], v[108:111], v[0:3]
    v_mfma_f32_16x16x32_bf16 v[4:7], a[172:175], v[124:127], v[4:7]
    v_mfma_f32_16x16x32_bf16 v[8:11], a[172:175], v[140:143], v[8:11]
    v_mfma_f32_16x16x32_bf16 v[12:15], a[172:175], v[156:159], v[12:15]
    v_mfma_f32_16x16x32_bf16 v[16:19], a[172:175], v[172:175], v[16:19]
    ds_read_b128 a[172:175], v81 offset:17920
    v_mfma_f32_16x16x32_bf16 v[20:23], a[176:179], v[96:99], 0
    v_mfma_f32_16x16x32_bf16 v[24:27], a[176:179], v[112:115], 0
    v_mfma_f32_16x16x32_bf16 v[28:31], a[176:179], v[128:131], 0
    v_mfma_f32_16x16x32_bf16 v[32:35], a[176:179], v[144:147], 0
    v_mfma_f32_16x16x32_bf16 v[36:39], a[176:179], v[160:163], 0
    ds_read_b128 a[176:179], v81 offset:20480
    v_mfma_f32_16x16x32_bf16 v[20:23], a[180:183], v[100:103], v[20:23]
    v_mfma_f32_16x16x32_bf16 v[24:27], a[180:183], v[116:119], v[24:27]
    v_mfma_f32_16x16x32_bf16 v[28:31], a[180:183], v[132:135], v[28:31]
    v_mfma_f32_16x16x32_bf16 v[32:35], a[180:183], v[148:151], v[32:35]
    v_mfma_f32_16x16x32_bf16 v[36:39], a[180:183], v[164:167], v[36:39]
    ds_read_b128 a[180:183], v81 offset:20992
    v_mfma_f32_16x16x32_bf16 v[20:23], a[184:187], v[104:107], v[20:23]
    v_mfma_f32_16x16x32_bf16 v[24:27], a[184:187], v[120:123], v[24:27]
    v_mfma_f32_16x16x32_bf16 v[28:31], a[184:187], v[136:139], v[28:31]
    v_mfma_f32_16x16x32_bf16 v[32:35], a[184:187], v[152:155], v[32:35]
    v_mfma_f32_16x16x32_bf16 v[36:39], a[184:187], v[168:171], v[36:39]
    ds_read_b128 a[184:187], v81 offset:21504
    v_mfma_f32_16x16x32_bf16 v[20:23], a[188:191], v[108:111], v[20:23]
    v_mfma_f32_16x16x32_bf16 v[24:27], a[188:191], v[124:127], v[24:27]
    v_mfma_f32_16x16x32_bf16 v[28:31], a[188:191], v[140:143], v[28:31]
    v_mfma_f32_16x16x32_bf16 v[32:35], a[188:191], v[156:159], v[32:35]
    v_mfma_f32_16x16x32_bf16 v[36:39], a[188:191], v[172:175], v[36:39]
    ds_read_b128 a[188:191], v81 offset:22016
    s_nop 7
    s_branch L_have_max
L_k1_end:
    s_endpgm
.globl oproj_kernel
.p2align 8
.type oproj_kernel,@function
oproj_kernel:
    s_cmp_ge_u32 s2, 720
    s_cbranch_scc1 L_k2_end
    s_load_dwordx2 s[32:33], s[0:1], 80
    s_load_dwordx2 s[34:35], s[0:1], 96
    v_and_b32 v1, 63, v0
    v_lshrrev_b32 v2, 6, v0
    s_lshl_b32 s13, s2, 2
    v_readfirstlane_b32 s12, v2
    v_lshlrev_b32 v3, 4, v1
    s_add_u32 s13, s13, s12
    s_mul_hi_u32 s14, s13, 23860930
    s_mul_i32 s15, s14, 180
    s_sub_u32 s15, s13, s15
    s_mul_i32 s16, s14, 2880
    s_add_u32 s16, s16, s15
    s_lshl_b32 s16, s16, 10
    s_waitcnt lgkmcnt(0)
    s_add_u32 s4, s34, 0
    s_addc_u32 s5, s35, 0
    s_and_b32 s5, s5, 0xffff
    s_mov_b32 s6, 47185920
    s_mov_b32 s7, 0x20000
    s_mov_b32 s8, s32
    s_and_b32 s9, s33, 0xffff
    s_mov_b32 s10, 2949120
    s_mov_b32 s11, 0x20000
    buffer_load_dwordx4 v[16:19], v3, s[4:7], s16 offen
    s_add_u32 s16, s16, 184320
    buffer_load_dwordx4 v[20:23], v3, s[4:7], s16 offen
    s_add_u32 s16, s16, 184320
    buffer_load_dwordx4 v[24:27], v3, s[4:7], s16 offen
    s_add_u32 s16, s16, 184320
    buffer_load_dwordx4 v[28:31], v3, s[4:7], s16 offen
    s_add_u32 s16, s16, 184320
    buffer_load_dwordx4 v[32:35], v3, s[4:7], s16 offen
    s_add_u32 s16, s16, 184320
    buffer_load_dwordx4 v[36:39], v3, s[4:7], s16 offen
    s_add_u32 s16, s16, 184320
    buffer_load_dwordx4 v[40:43], v3, s[4:7], s16 offen
    s_add_u32 s16, s16, 184320
    buffer_load_dwordx4 v[44:47], v3, s[4:7], s16 offen
    s_add_u32 s16, s16, 184320
    buffer_load_dwordx4 v[48:51], v3, s[4:7], s16 offen
    s_add_u32 s16, s16, 184320
    buffer_load_dwordx4 v[52:55], v3, s[4:7], s16 offen
    s_add_u32 s16, s16, 184320
    buffer_load_dwordx4 v[56:59], v3, s[4:7], s16 offen
    s_add_u32 s16, s16, 184320
    buffer_load_dwordx4 v[60:63], v3, s[4:7], s16 offen
    s_add_u32 s16, s16, 184320
    buffer_load_dwordx4 v[64:67], v3, s[4:7], s16 offen
    s_add_u32 s16, s16, 184320
    buffer_load_dwordx4 v[68:71], v3, s[4:7], s16 offen
    s_add_u32 s16, s16, 184320
    buffer_load_dwordx4 v[72:75], v3, s[4:7], s16 offen
    s_add_u32 s16, s16, 184320
    buffer_load_dwordx4 v[76:79], v3, s[4:7], s16 offen
    s_mul_hi_u32 s17, s15, 429496730
    s_mul_i32 s18, s17, 10
    s_sub_u32 s18, s15, s18
    s_and_b32 s19, s14, 7
    s_lshr_b32 s20, s14, 3
    s_mul_i32 s19, s19, 160
    s_lshl_b32 s18, s18, 4
    s_add_u32 s19, s19, s18
    s_mul_i32 s19, s19, 2304
    s_mul_i32 s20, s20, 1152
    s_add_u32 s19, s19, s20
    s_lshl_b32 s17, s17, 6
    s_add_u32 s19, s19, s17
    v_and_b32 v4, 15, v1
    v_lshrrev_b32 v5, 4, v1
    s_movk_i32 s21, 2304
    v_lshlrev_b32 v5, 4, v5
    v_mad_u32_u24 v4, v4, s21, v5
    v_and_b32 v5, 15, v1
    v_lshrrev_b32 v6, 4, v1
    v_lshrrev_b32 v7, 2, v5
    v_cmp_eq_u32 vcc, v6, v7
    v_and_b32 v5, 3, v5
    v_and_b32 v7, 1, v5
    v_lshlrev_b32 v7, 4, v7
    v_mov_b32 v6, 0x3f80
    v_lshlrev_b32 v6, v7, v6
    v_cndmask_b32 v6, 0, v6, vcc
    v_lshrrev_b32 v5, 1, v5
    v_cmp_eq_u32 vcc, 0, v5
    v_mov_b32 v10, 0
    v_mov_b32 v11, 0
    v_cndmask_b32 v8, 0, v6, vcc
    v_cndmask_b32 v9, v6, 0, vcc
    v_mov_b32 v12, 0
    v_mov_b32 v13, 0
    v_mov_b32 v14, v8
    v_mov_b32 v15, v9
    s_waitcnt vmcnt(15)
    v_mfma_f32_16x16x32_bf16 v[80:83], v[8:11], v[16:19], 0
    v_mfma_f32_16x16x32_bf16 v[84:87], v[12:15], v[16:19], 0
    s_waitcnt vmcnt(14)
    v_mfma_f32_16x16x32_bf16 v[80:83], v[8:11], v[20:23], v[80:83]
    v_mfma_f32_16x16x32_bf16 v[84:87], v[12:15], v[20:23], v[84:87]
    s_waitcnt vmcnt(13)
    v_mfma_f32_16x16x32_bf16 v[80:83], v[8:11], v[24:27], v[80:83]
    v_mfma_f32_16x16x32_bf16 v[84:87], v[12:15], v[24:27], v[84:87]
    s_waitcnt vmcnt(12)
    v_mfma_f32_16x16x32_bf16 v[80:83], v[8:11], v[28:31], v[80:83]
    v_mfma_f32_16x16x32_bf16 v[84:87], v[12:15], v[28:31], v[84:87]
    s_waitcnt vmcnt(11)
    v_mfma_f32_16x16x32_bf16 v[80:83], v[8:11], v[32:35], v[80:83]
    v_mfma_f32_16x16x32_bf16 v[84:87], v[12:15], v[32:35], v[84:87]
    s_waitcnt vmcnt(10)
    v_mfma_f32_16x16x32_bf16 v[80:83], v[8:11], v[36:39], v[80:83]
    v_mfma_f32_16x16x32_bf16 v[84:87], v[12:15], v[36:39], v[84:87]
    s_waitcnt vmcnt(9)
    v_mfma_f32_16x16x32_bf16 v[80:83], v[8:11], v[40:43], v[80:83]
    v_mfma_f32_16x16x32_bf16 v[84:87], v[12:15], v[40:43], v[84:87]
    s_waitcnt vmcnt(8)
    v_mfma_f32_16x16x32_bf16 v[80:83], v[8:11], v[44:47], v[80:83]
    v_mfma_f32_16x16x32_bf16 v[84:87], v[12:15], v[44:47], v[84:87]
    s_waitcnt vmcnt(7)
    v_mfma_f32_16x16x32_bf16 v[80:83], v[8:11], v[48:51], v[80:83]
    v_mfma_f32_16x16x32_bf16 v[84:87], v[12:15], v[48:51], v[84:87]
    s_waitcnt vmcnt(6)
    v_mfma_f32_16x16x32_bf16 v[80:83], v[8:11], v[52:55], v[80:83]
    v_mfma_f32_16x16x32_bf16 v[84:87], v[12:15], v[52:55], v[84:87]
    s_waitcnt vmcnt(5)
    v_mfma_f32_16x16x32_bf16 v[80:83], v[8:11], v[56:59], v[80:83]
    v_mfma_f32_16x16x32_bf16 v[84:87], v[12:15], v[56:59], v[84:87]
    s_waitcnt vmcnt(4)
    v_mfma_f32_16x16x32_bf16 v[80:83], v[8:11], v[60:63], v[80:83]
    v_mfma_f32_16x16x32_bf16 v[84:87], v[12:15], v[60:63], v[84:87]
    s_waitcnt vmcnt(3)
    v_mfma_f32_16x16x32_bf16 v[80:83], v[8:11], v[64:67], v[80:83]
    v_mfma_f32_16x16x32_bf16 v[84:87], v[12:15], v[64:67], v[84:87]
    s_waitcnt vmcnt(2)
    v_mfma_f32_16x16x32_bf16 v[80:83], v[8:11], v[68:71], v[80:83]
    v_mfma_f32_16x16x32_bf16 v[84:87], v[12:15], v[68:71], v[84:87]
    s_waitcnt vmcnt(1)
    v_mfma_f32_16x16x32_bf16 v[80:83], v[8:11], v[72:75], v[80:83]
    v_mfma_f32_16x16x32_bf16 v[84:87], v[12:15], v[72:75], v[84:87]
    s_waitcnt vmcnt(0)
    v_mfma_f32_16x16x32_bf16 v[80:83], v[8:11], v[76:79], v[80:83]
    v_mfma_f32_16x16x32_bf16 v[84:87], v[12:15], v[76:79], v[84:87]
    s_nop 7
    v_cvt_pk_bf16_f32 v16, v80, v81
    v_cvt_pk_bf16_f32 v17, v82, v83
    v_cvt_pk_bf16_f32 v18, v84, v85
    v_cvt_pk_bf16_f32 v19, v86, v87
    buffer_store_dwordx4 v[16:19], v4, s[8:11], s19 offen
L_k2_end:
    s_endpgm
L_code_end:
.section .rodata,"a"
.p2align 6
.amdhsa_kernel concat_heads__gqa_block_cached__gqa_block_cached__near_ridge_kernel
  .amdhsa_next_free_vgpr 512
  .amdhsa_next_free_sgpr 102
  .amdhsa_accum_offset 256
  .amdhsa_group_segment_fixed_size 0
  .amdhsa_kernarg_size 104
  .amdhsa_user_sgpr_count 2
  .amdhsa_user_sgpr_kernarg_segment_ptr 1
  .amdhsa_system_sgpr_workgroup_id_x 1
.end_amdhsa_kernel
.p2align 6
.amdhsa_kernel oproj_kernel
  .amdhsa_next_free_vgpr 88
  .amdhsa_next_free_sgpr 40
  .amdhsa_accum_offset 88
  .amdhsa_group_segment_fixed_size 0
  .amdhsa_kernarg_size 104
  .amdhsa_user_sgpr_count 2
  .amdhsa_user_sgpr_kernarg_segment_ptr 1
  .amdhsa_system_sgpr_workgroup_id_x 1
.end_amdhsa_kernel
```
